```python
import torch

def _softmax(x, axis=-1):
    return torch.softmax(x, dim=axis)
def _gelu(x):
    return torch.nn.functional.gelu(x, approximate="tanh")
def _silu(x):
    return torch.nn.functional.silu(x)
def _sigmoid(x):
    return torch.sigmoid(x)
def _layernorm(x, axis=-1, eps=1e-5):
    m = x.mean(dim=axis, keepdim=True)
    v = x.var(dim=axis, keepdim=True, unbiased=False)
    return (x - m) / torch.sqrt(v + eps)
def _scatter_add(tgt, idx, src, axis=0):
    return tgt.clone().index_add_(axis, idx, src)
def _segment_sum(src, seg, n):
    out = torch.zeros((n,) + src.shape[1:], dtype=src.dtype)
    return out.index_add_(0, seg, src)
def _pad(x, pw):
    flat = tuple(v for pair in reversed(pw) for v in pair)
    return torch.nn.functional.pad(x, flat)

kernel_name = 'standalone__mha_block_cached__near_ridge'

def setup_inputs():

    _w = (lambda a: (lambda t: t.to(torch.bfloat16) if t.is_floating_point() else t)(torch.as_tensor(a)))
    B, Sq, D = 32, 160, 640
    H, Sk, Dh = 32, 512, 128
    return {
        "x": _w((lambda *s: torch.randn(*s, dtype=torch.bfloat16) * 0.8)(B, Sq, D)),
        "k_cache": _w((lambda *s: torch.randn(*s, dtype=torch.bfloat16) * 0.8)(B, H, Sk, Dh)),
        "v_cache": _w((lambda *s: torch.randn(*s, dtype=torch.bfloat16) * 0.05)(B, H, Sk, Dh)),
        "wq": _w((lambda *s: torch.randn(*s, dtype=torch.bfloat16) * 0.8)(D, H * Dh) * (D ** -0.5)),
        "wo": _w((lambda *s: torch.randn(*s, dtype=torch.bfloat16) * 0.05)(H * Dh, D) * ((H * Dh) ** -0.5)),
    }

def reference(x, k_cache, v_cache, wq, wo):
    B, Sq, D = x.shape
    H, Dh = 32, 128
    q = (lambda x, *d: x.permute(*d))((x @ wq).reshape(B, Sq, H, Dh), 0, 2, 1, 3)
    scores = torch.einsum("bhqd,bhkd->bhqk", q, k_cache) * (Dh ** -0.5)
    p = _softmax(scores, axis=-1)
    o = torch.einsum("bhqk,bhkd->bhqd", p, v_cache)
    return (lambda x, *d: x.permute(*d))(o, 0, 2, 1, 3).reshape(B, Sq, H * Dh) @ wo
```

```asm
; @launch grid=(256,1,1) block=(256,1,1) lds=162816
.amdgcn_target "amdgcn-amd-amdhsa--gfx950"
.text
.globl standalone__mha_block_cached__near_ridge_kernel
.p2align 8
.type standalone__mha_block_cached__near_ridge_kernel,@function
standalone__mha_block_cached__near_ridge_kernel:
    s_cmp_ge_u32 s2, 256
    s_cbranch_scc1 L_exit
    s_load_dwordx8 s[56:63], s[0:1], 0
    s_load_dwordx8 s[64:71], s[0:1], 32
    v_lshrrev_b32 v1, 6, v0
    v_and_b32 v0, 63, v0
    v_lshlrev_b32 v204, 4, v0
    v_readfirstlane_b32 s28, v1
    s_bfe_u32 s29, s2, 0x20001
    s_lshl_b32 s29, s29, 3
    s_lshr_b32 s41, s2, 5
    s_add_u32 s29, s29, s41
    s_and_b32 s30, s2, 1
    s_lshl_b32 s30, s30, 2
    s_bfe_u32 s45, s2, 0x20003
    s_add_u32 s30, s30, s45
    s_add_u32 s45, s45, s41
    s_mul_i32 s44, s45, 205
    s_lshr_b32 s44, s44, 10
    s_mul_i32 s44, s44, 5
    s_sub_u32 s35, s45, s44
    s_lshr_b32 s42, s28, 1
    v_lshrrev_b32 v1, 4, v0
    v_and_b32 v2, 0xf0, v204
    v_and_b32 v3, 1, v1
    v_lshrrev_b32 v5, 1, v1
    v_lshl_add_u32 v4, v3, 1, v5
    v_mul_u32_u24 v210, 10240, v4
    v_lshlrev_b32 v4, 4, v3
    v_xor_b32 v4, v4, v2
    v_add_u32 v210, v210, v4
    v_lshl_add_u32 v4, v5, 2, v3
    v_lshl_add_u32 v211, v4, 15, v2
    s_mul_i32 s53, s28, 2112
    s_mul_i32 s54, s28, 1280
    s_mul_i32 s37, s28, 8448
    s_and_b32 s39, s28, 1
    s_lshl_b32 s38, s39, 18
    s_lshl_b32 s39, s42, 8
    s_add_u32 s38, s38, s39
    s_mul_i32 s44, s29, 204800
    s_lshl_b32 s45, s30, 10
    s_sub_u32 s31, 5242880, s45
    s_mov_b32 s34, 0
    s_waitcnt lgkmcnt(0)
    s_add_u32 s20, s56, s44
    s_addc_u32 s21, s57, 0
    s_mov_b32 s22, 204800
    s_mov_b32 s23, 0x20000
    s_add_u32 s12, s62, s45
    s_addc_u32 s13, s63, 0
    s_mov_b32 s14, s31
    s_mov_b32 s15, 0x20000
    s_call_b64 s[50:51], S_qpx
    s_branch L_setup
S_qpx:
    s_mov_b32 s36, s35
    s_lshl_b32 s55, s36, 8
    s_add_u32 s55, s55, s54
    s_add_u32 m0, s53, 118272
    s_add_u32 s39, s55, 0
    buffer_load_dwordx4 v210, s[20:23], s39 offen lds
    s_add_u32 m0, s53, 119328
    s_add_u32 s39, s55, 5120
    buffer_load_dwordx4 v210, s[20:23], s39 offen lds
    s_add_u32 m0, s53, 126720
    s_add_u32 s39, s55, 40960
    buffer_load_dwordx4 v210, s[20:23], s39 offen lds
    s_add_u32 m0, s53, 127776
    s_add_u32 s39, s55, 46080
    buffer_load_dwordx4 v210, s[20:23], s39 offen lds
    s_add_u32 m0, s53, 135168
    s_add_u32 s39, s55, 81920
    buffer_load_dwordx4 v210, s[20:23], s39 offen lds
    s_add_u32 m0, s53, 136224
    s_add_u32 s39, s55, 87040
    buffer_load_dwordx4 v210, s[20:23], s39 offen lds
    s_add_u32 m0, s53, 143616
    s_add_u32 s39, s55, 122880
    buffer_load_dwordx4 v210, s[20:23], s39 offen lds
    s_add_u32 m0, s53, 144672
    s_add_u32 s39, s55, 128000
    buffer_load_dwordx4 v210, s[20:23], s39 offen lds
    s_add_u32 m0, s53, 152064
    s_add_u32 s39, s55, 163840
    buffer_load_dwordx4 v210, s[20:23], s39 offen lds
    s_add_u32 m0, s53, 153120
    s_add_u32 s39, s55, 168960
    buffer_load_dwordx4 v210, s[20:23], s39 offen lds
    s_add_u32 s43, s37, 0
    s_lshl_b32 s46, s36, 20
    s_add_u32 s46, s46, s38
    s_add_u32 m0, s43, 0
    s_add_u32 s39, s46, 0
    buffer_load_dwordx4 v211, s[12:15], s39 offen lds
    s_add_u32 m0, s43, 1056
    s_add_u32 s39, s46, 65536
    buffer_load_dwordx4 v211, s[12:15], s39 offen lds
    s_add_u32 m0, s43, 2112
    s_add_u32 s39, s46, 8192
    buffer_load_dwordx4 v211, s[12:15], s39 offen lds
    s_add_u32 m0, s43, 3168
    s_add_u32 s39, s46, 73728
    buffer_load_dwordx4 v211, s[12:15], s39 offen lds
    s_setpc_b64 s[50:51]
L_setup:
    v_lshl_add_u32 v4, v3, 1, v5
    v_lshlrev_b32 v4, 1, v4
    v_mul_u32_u24 v243, 5120, v4
    v_add_u32 v243, v243, v2
    v_bfe_u32 v6, v0, 3, 1
    v_mul_u32_u24 v6, 163840, v6
    v_sub_u32 v244, v243, v6
    v_add_u32 v244, 163840, v244
    v_add_u32 v243, v243, v6
    v_mul_u32_u24 v242, 1280, v1
    v_add_u32 v242, v242, v2
    s_lshl_b32 s39, s41, 2
    s_add_u32 s39, s39, s28
    s_mul_i32 s39, s39, 5120
    v_add_u32 v242, s39, v242
    s_add_u32 s72, s66, s44
    s_addc_u32 s73, s67, 0
    s_mov_b32 s74, 204800
    s_mov_b32 s75, 0x20000
    s_mov_b32 s76, s68
    s_mov_b32 s77, s69
    s_mov_b32 s78, 256
    s_mov_b32 s79, 0x20000
    s_mov_b32 s66, s70
    s_mov_b32 s67, s71
    s_lshl_b32 s39, s29, 3
    s_add_u32 s39, s39, s30
    s_lshl_b32 s45, s39, 19
    s_lshl_b32 s43, s42, 17
    s_add_u32 s45, s45, s43
    s_add_u32 s4, s58, s45
    s_addc_u32 s5, s59, 0
    s_mov_b32 s6, 131072
    s_mov_b32 s7, 0x20000
    s_add_u32 s8, s60, s45
    s_addc_u32 s9, s61, 0
    s_mov_b32 s10, 131072
    s_mov_b32 s11, 0x20000
    s_mul_i32 s45, s39, 204800
    s_add_u32 s24, s66, s45
    s_addc_u32 s25, s67, 0
    s_mov_b32 s26, 204800
    s_mov_b32 s27, 0x20000
    s_lshl_b32 s44, s44, 3
    s_add_u32 s60, s66, s44
    s_addc_u32 s61, s67, 0
    s_mov_b32 s62, 1638400
    s_mov_b32 s63, 0x20000
    s_lshl_b32 s44, s29, 10
    s_add_u32 s44, s44, 52428800
    s_add_u32 s68, s66, s44
    s_addc_u32 s69, s67, 0
    s_mov_b32 s70, 1024
    s_mov_b32 s71, 0x20000
    s_mul_i32 s44, s30, 655360
    s_add_u32 s16, s64, s44
    s_addc_u32 s17, s65, 0
    s_mov_b32 s18, 655360
    s_mov_b32 s19, 0x20000
    s_mov_b32 s40, 1040356334
    s_mov_b32 s57, 0xffff0000
    v_bfe_u32 v4, v0, 2, 2
    v_lshl_add_u32 v4, v4, 1, v3
    v_mul_u32_u24 v217, 1056, v4
    v_lshl_add_u32 v217, v5, 9, v217
    v_and_b32 v4, 0x30, v204
    v_lshrrev_b32 v6, 1, v4
    v_add_u32 v219, v217, v6
    v_add_u32 v217, v217, v4
    v_and_b32 v4, 3, v0
    v_bfe_u32 v6, v0, 2, 1
    v_lshl_add_u32 v4, v4, 1, v6
    v_mul_u32_u24 v7, 1056, v4
    v_bfe_u32 v6, v0, 3, 1
    v_lshl_add_u32 v7, v6, 9, v7
    v_xor_b32 v6, 1, v1
    v_lshl_add_u32 v8, v6, 4, v7
    v_add_u32 v8, 256, v8
    v_lshl_add_u32 v7, v1, 4, v7
    s_mul_i32 s32, s42, 67584
    v_add_u32 v205, s32, v7
    v_add_u32 v206, s32, v8
    s_add_u32 s33, s32, 33792
    v_add_u32 v207, s33, v219
    s_and_b32 s39, s28, 1
    s_mul_i32 s44, s39, 4224
    s_add_u32 s32, s32, s44
    s_add_u32 s33, s33, s44
    v_add_u32 v212, 118272, v7
    v_add_u32 v213, 118272, v8
    s_cmp_eq_u32 s39, 0
    s_cbranch_scc1 L_x0
    v_add_u32 v212, 135168, v8
    v_add_u32 v213, 143616, v7
L_x0:
    s_mul_i32 s44, s39, 20480
    s_lshl_b32 s45, s42, 11
    s_add_u32 s44, s44, s45
    v_add_u32 v245, s44, v204
    s_lshr_b32 s44, s30, 2
    s_and_b32 s45, s30, 3
    s_lshl_b32 s45, s45, 2
    s_add_u32 s45, s45, s28
    s_mul_i32 s43, s44, 20480
    s_lshl_b32 s46, s45, 8
    s_add_u32 s43, s43, s46
    s_mov_b32 s46, 204800
    v_mul_lo_u32 v240, s46, v1
    v_add3_u32 v240, v240, v2, s43
    s_mul_i32 s43, s44, 102400
    s_lshl_b32 s46, s45, 4
    s_add_u32 s43, s43, s46
    s_lshl_b32 s46, s28, 3
    s_sub_u32 s43, s43, s46
    v_and_b32 v4, 15, v0
    v_lshl_add_u32 v6, v5, 4, v4
    v_mul_u32_u24 v241, 1280, v6
    v_lshl_add_u32 v241, v3, 5, v241
    v_add_u32 v241, s43, v241
    v_mov_b32 v6, 2146435072
    v_cmp_gt_u32 s[44:45], 32, v0
    s_nop 1
    v_cndmask_b32 v223, v6, v241, s[44:45]
    v_and_b32 v6, 1, v0
    v_lshlrev_b32 v6, 4, v6
    v_mov_b32 v9, 0x3f80
    v_lshlrev_b32 v6, v6, v9
    v_lshrrev_b32 v4, 1, v4
    v_cmp_eq_u32 s[44:45], 0, v4
    s_nop 1
    v_cndmask_b32 v224, 0, v6, s[44:45]
    v_cmp_eq_u32 s[44:45], 1, v4
    s_nop 1
    v_cndmask_b32 v225, 0, v6, s[44:45]
    v_cmp_eq_u32 s[44:45], 2, v4
    s_nop 1
    v_cndmask_b32 v226, 0, v6, s[44:45]
    v_cmp_eq_u32 s[44:45], 3, v4
    s_nop 1
    v_cndmask_b32 v227, 0, v6, s[44:45]
    v_cmp_eq_u32 s[44:45], 4, v4
    s_nop 1
    v_cndmask_b32 v228, 0, v6, s[44:45]
    v_cmp_eq_u32 s[44:45], 5, v4
    s_nop 1
    v_cndmask_b32 v229, 0, v6, s[44:45]
    v_cmp_eq_u32 s[44:45], 6, v4
    s_nop 1
    v_cndmask_b32 v230, 0, v6, s[44:45]
    v_cmp_eq_u32 s[44:45], 7, v4
    s_nop 1
    v_cndmask_b32 v231, 0, v6, s[44:45]
    v_mov_b32 v200, 0x3f803f80
    v_mov_b32 v201, 0x3f803f80
    v_mov_b32 v202, 0x3f803f80
    v_mov_b32 v203, 0x3f803f80
    v_mov_b32 v249, 0
    v_mov_b64 v[232:233], 0
    v_mov_b64 v[234:235], 0
    s_lshl_b32 s39, s30, 3
    s_add_u32 s39, s39, s28
    s_cmp_eq_u32 s39, 1
    s_cbranch_scc1 L_fi
L_fib:
    s_getpc_b64 s[44:45]
L_pc:
    s_sub_u32 s44, s44, L_pc-standalone__mha_block_cached__near_ridge_kernel
    s_subb_u32 s45, s45, 0
    s_lshr_b32 s39, s2, 3
    s_lshl_b32 s39, s39, 1
    s_add_u32 s39, s39, s42
    s_lshl_b32 s39, s39, 10
    s_min_u32 s39, s39, L_code_end-standalone__mha_block_cached__near_ridge_kernel-1024
    v_add_u32 v196, s39, v204
    s_bitcmp1_b32 s28, 0
    s_cbranch_scc1 L_ncw
    global_load_dwordx4 v[252:255], v196, s[44:45]
L_ncw:
    s_mov_b32 s39, 0
    s_lshl_b32 s39, s39, 14
    v_mov_b32 v222, s39
L_round:
    s_and_b32 s39, s28, 1
    s_lshl_b32 s39, s39, 12
    v_add3_u32 v209, s39, v204, v222
    v_bfe_u32 v251, v204, 8, 1
    v_lshlrev_b32 v251, 4, v251
    v_xor_b32 v208, v251, v209
    s_mul_i32 s39, s42, 16896
    v_add_u32 v214, s39, v217
    v_add_u32 v215, 67584, v214
    v_add_u32 v216, 33792, v214
    s_add_u32 s48, s37, 0
    s_add_u32 s49, s37, 67584
    s_add_u32 s52, s37, 33792
    s_mov_b32 s31, 0
    v_mov_b64 v[232:233], 0
    v_mov_b64 v[234:235], 0
    s_nop 1
    v_mfma_f32_32x32x16_bf16 v[0:15], v[232:235], v[232:235], 0
    v_mfma_f32_32x32x16_bf16 v[16:31], v[232:235], v[232:235], 0
    v_mfma_f32_32x32x16_bf16 v[32:47], v[232:235], v[232:235], 0
    v_mfma_f32_32x32x16_bf16 v[48:63], v[232:235], v[232:235], 0
    v_mfma_f32_32x32x16_bf16 v[64:79], v[232:235], v[232:235], 0
    v_mfma_f32_32x32x16_bf16 v[80:95], v[232:235], v[232:235], 0
    v_mfma_f32_32x32x16_bf16 v[96:111], v[232:235], v[232:235], 0
    v_mfma_f32_32x32x16_bf16 v[112:127], v[232:235], v[232:235], 0
    v_mfma_f32_32x32x16_bf16 v[128:143], v[232:235], v[232:235], 0
    v_mfma_f32_32x32x16_bf16 v[144:159], v[232:235], v[232:235], 0
    v_accvgpr_write_b32 a240, 0
    v_accvgpr_write_b32 a241, 0
    v_accvgpr_write_b32 a242, 0
    v_accvgpr_write_b32 a243, 0
    v_accvgpr_write_b32 a244, 0
    v_accvgpr_write_b32 a245, 0
    v_accvgpr_write_b32 a246, 0
    v_accvgpr_write_b32 a247, 0
    v_accvgpr_write_b32 a12, 0
    v_accvgpr_write_b32 a13, 0
    v_accvgpr_write_b32 a14, 0
    v_accvgpr_write_b32 a15, 0
    v_accvgpr_write_b32 a28, 0
    v_accvgpr_write_b32 a29, 0
    v_accvgpr_write_b32 a30, 0
    v_accvgpr_write_b32 a31, 0
    v_accvgpr_write_b32 a44, 0
    v_accvgpr_write_b32 a45, 0
    v_accvgpr_write_b32 a46, 0
    v_accvgpr_write_b32 a47, 0
    v_accvgpr_write_b32 a60, 0
    v_accvgpr_write_b32 a61, 0
    v_accvgpr_write_b32 a62, 0
    v_accvgpr_write_b32 a63, 0
    v_accvgpr_write_b32 a76, 0
    v_accvgpr_write_b32 a77, 0
    v_accvgpr_write_b32 a78, 0
    v_accvgpr_write_b32 a79, 0
    s_cmp_eq_u32 s34, 1
    s_cbranch_scc1 L_rw2
    s_add_u32 s43, s37, 0
    s_lshl_b32 s46, s36, 20
    s_add_u32 s46, s46, s38
    s_add_u32 m0, s43, 4224
    s_add_u32 s39, s46, 16384
    buffer_load_dwordx4 v211, s[12:15], s39 offen lds
    s_add_u32 m0, s43, 5280
    s_add_u32 s39, s46, 81920
    buffer_load_dwordx4 v211, s[12:15], s39 offen lds
    s_add_u32 m0, s43, 6336
    s_add_u32 s39, s46, 24576
    buffer_load_dwordx4 v211, s[12:15], s39 offen lds
    s_add_u32 m0, s43, 7392
    s_add_u32 s39, s46, 90112
    buffer_load_dwordx4 v211, s[12:15], s39 offen lds
    s_waitcnt vmcnt(0)
    s_barrier
    ds_read_b128 a[0:3], v212 offset:0
    ds_read_b128 a[16:19], v213 offset:0
    ds_read_b128 a[32:35], v212 offset:8448
    ds_read_b128 a[48:51], v213 offset:8448
    ds_read_b128 a[64:67], v212 offset:16896
    ds_read_b128 a[4:7], v212 offset:64
    ds_read_b128 a[20:23], v213 offset:64
    ds_read_b128 a[36:39], v212 offset:8512
    ds_read_b128 a[52:55], v213 offset:8512
    ds_read_b128 a[68:71], v212 offset:16960
    s_waitcnt lgkmcnt(0)
    ds_read_b128 a[80:83], v212 offset:128
    ds_read_b128 a[88:91], v213 offset:128
    ds_read_b128 a[96:99], v212 offset:8576
    ds_read_b128 a[104:107], v213 offset:8576
    ds_read_b128 a[112:115], v212 offset:17024
    ds_read_b128 a[84:87], v212 offset:192
    ds_read_b128 a[92:95], v213 offset:192
    ds_read_b128 a[100:103], v212 offset:8640
    ds_read_b128 a[108:111], v213 offset:8640
    ds_read_b128 a[116:119], v212 offset:17088
    s_add_u32 m0, s49, 0
    s_add_u32 s39, s46, 524288
    buffer_load_dwordx4 v211, s[12:15], s39 offen lds
    s_add_u32 m0, s49, 1056
    s_add_u32 s39, s46, 589824
    buffer_load_dwordx4 v211, s[12:15], s39 offen lds
    s_add_u32 m0, s49, 2112
    s_add_u32 s39, s46, 532480
    buffer_load_dwordx4 v211, s[12:15], s39 offen lds
    s_add_u32 m0, s49, 3168
    s_add_u32 s39, s46, 598016
    buffer_load_dwordx4 v211, s[12:15], s39 offen lds
    s_add_u32 m0, s49, 4224
    s_add_u32 s39, s46, 540672
    buffer_load_dwordx4 v211, s[12:15], s39 offen lds
    s_add_u32 m0, s49, 5280
    s_add_u32 s39, s46, 606208
    buffer_load_dwordx4 v211, s[12:15], s39 offen lds
    s_add_u32 m0, s49, 6336
    s_add_u32 s39, s46, 548864
    buffer_load_dwordx4 v211, s[12:15], s39 offen lds
    s_add_u32 m0, s49, 7392
    s_add_u32 s39, s46, 614400
    buffer_load_dwordx4 v211, s[12:15], s39 offen lds
L_rw2:
    s_waitcnt lgkmcnt(0)
    s_barrier
    v_mov_b32 v221, 2146435072
    v_mov_b32 v247, 2146435072
    s_movk_i32 s58, 0x2000
L_Q_loop:
    s_add_u32 s36, s36, 1
    s_cmp_ge_u32 s36, 5
    s_cselect_b32 s36, 0, s36
    s_lshl_b32 s55, s36, 8
    s_add_u32 s55, s55, s54
    s_lshl_b32 s46, s36, 20
    s_add_u32 s46, s46, s38
    s_cmp_eq_u32 s31, 3
    s_cselect_b32 s43, 0x30000, s48
    s_cmp_eq_u32 s31, 2
    s_cbranch_scc1 L_Q_en
L_Q_enb:
    v_mfma_f32_16x16x32_bf16 v[24:27], a[240:243], a[12:15], v[24:27]
    ds_read_b64_tr_b16 a[248:249], v214 offset:0
    ds_read_b64_tr_b16 a[250:251], v214 offset:256
    v_mfma_f32_16x16x32_bf16 v[56:59], a[240:243], a[28:31], v[56:59]
    ds_read_b64_tr_b16 a[252:253], v214 offset:8
    ds_read_b64_tr_b16 a[254:255], v214 offset:264
    v_mfma_f32_16x16x32_bf16 v[88:91], a[240:243], a[44:47], v[88:91]
    s_add_u32 m0, s53, 118272
    s_add_u32 s39, s55, 0
    v_accvgpr_mov_b32 a8, a80
    v_mfma_f32_16x16x32_bf16 v[120:123], a[240:243], a[60:63], v[120:123]
    buffer_load_dwordx4 v210, s[20:23], s39 offen lds
    v_mfma_f32_16x16x32_bf16 v[152:155], a[240:243], a[76:79], v[152:155]
    s_add_u32 m0, s53, 119328
    s_add_u32 s39, s55, 5120
    v_accvgpr_mov_b32 a9, a81
    v_mfma_f32_16x16x32_bf16 v[28:31], a[244:247], a[12:15], v[28:31]
    ds_read_b64_tr_b16 a[240:241], v214 offset:64
    v_mfma_f32_16x16x32_bf16 v[60:63], a[244:247], a[28:31], v[60:63]
    ds_read_b64_tr_b16 a[242:243], v214 offset:320
    v_mfma_f32_16x16x32_bf16 v[92:95], a[244:247], a[44:47], v[92:95]
    buffer_load_dwordx4 v210, s[20:23], s39 offen lds
    v_accvgpr_mov_b32 a10, a82
    v_mfma_f32_16x16x32_bf16 v[124:127], a[244:247], a[60:63], v[124:127]
    s_add_u32 m0, s53, 126720
    s_add_u32 s39, s55, 40960
    v_mfma_f32_16x16x32_bf16 v[156:159], a[244:247], a[76:79], v[156:159]
    v_accvgpr_mov_b32 a11, a83
    s_waitcnt lgkmcnt(4)
    v_mfma_f32_16x16x32_bf16 v[0:3], a[248:251], a[0:3], v[0:3]
    ds_read_b64_tr_b16 a[244:245], v214 offset:72
    v_mfma_f32_16x16x32_bf16 v[32:35], a[248:251], a[16:19], v[32:35]
    ds_read_b64_tr_b16 a[246:247], v214 offset:328
    v_accvgpr_mov_b32 a24, a88
    v_mfma_f32_16x16x32_bf16 v[64:67], a[248:251], a[32:35], v[64:67]
    buffer_load_dwordx4 v210, s[20:23], s39 offen lds
    v_mfma_f32_16x16x32_bf16 v[96:99], a[248:251], a[48:51], v[96:99]
    s_add_u32 m0, s53, 127776
    v_accvgpr_mov_b32 a25, a89
    v_mfma_f32_16x16x32_bf16 v[128:131], a[248:251], a[64:67], v[128:131]
    v_accvgpr_mov_b32 a26, a90
    s_waitcnt lgkmcnt(4)
    v_mfma_f32_16x16x32_bf16 v[4:7], a[252:255], a[0:3], v[4:7]
    ds_read_b64_tr_b16 a[248:249], v214 offset:128
    v_mfma_f32_16x16x32_bf16 v[36:39], a[252:255], a[16:19], v[36:39]
    ds_read_b64_tr_b16 a[250:251], v214 offset:384
    v_mfma_f32_16x16x32_bf16 v[68:71], a[252:255], a[32:35], v[68:71]
    s_add_u32 s39, s55, 46080
    buffer_load_dwordx4 v210, s[20:23], s39 offen lds
    v_mfma_f32_16x16x32_bf16 v[100:103], a[252:255], a[48:51], v[100:103]
    s_add_u32 m0, s53, 135168
    v_accvgpr_mov_b32 a27, a91
    v_mfma_f32_16x16x32_bf16 v[132:135], a[252:255], a[64:67], v[132:135]
    v_accvgpr_mov_b32 a40, a96
    s_waitcnt lgkmcnt(2)
    v_mfma_f32_16x16x32_bf16 v[8:11], a[240:243], a[0:3], v[8:11]
    ds_read_b64_tr_b16 a[252:253], v214 offset:136
    v_mfma_f32_16x16x32_bf16 v[40:43], a[240:243], a[16:19], v[40:43]
    ds_read_b64_tr_b16 a[254:255], v214 offset:392
    v_accvgpr_mov_b32 a41, a97
    v_mfma_f32_16x16x32_bf16 v[72:75], a[240:243], a[32:35], v[72:75]
    s_add_u32 s39, s55, 81920
    buffer_load_dwordx4 v210, s[20:23], s39 offen lds
    v_mfma_f32_16x16x32_bf16 v[104:107], a[240:243], a[48:51], v[104:107]
    s_add_u32 m0, s53, 136224
    v_accvgpr_mov_b32 a42, a98
    v_mfma_f32_16x16x32_bf16 v[136:139], a[240:243], a[64:67], v[136:139]
    s_add_u32 s39, s55, 87040
    v_accvgpr_mov_b32 a43, a99
    v_mfma_f32_16x16x32_bf16 v[12:15], a[244:247], a[0:3], v[12:15]
    ds_read_b64_tr_b16 a[240:241], v214 offset:192
    v_mfma_f32_16x16x32_bf16 v[44:47], a[244:247], a[16:19], v[44:47]
    ds_read_b64_tr_b16 a[242:243], v214 offset:448
    v_mfma_f32_16x16x32_bf16 v[76:79], a[244:247], a[32:35], v[76:79]
    buffer_load_dwordx4 v210, s[20:23], s39 offen lds
    s_add_u32 m0, s53, 143616
    v_mfma_f32_16x16x32_bf16 v[108:111], a[244:247], a[48:51], v[108:111]
    s_add_u32 s39, s55, 122880
    v_accvgpr_mov_b32 a56, a104
    v_mfma_f32_16x16x32_bf16 v[140:143], a[244:247], a[64:67], v[140:143]
    v_accvgpr_mov_b32 a57, a105
    s_waitcnt lgkmcnt(2)
    v_mfma_f32_16x16x32_bf16 v[16:19], a[248:251], a[0:3], v[16:19]
    ds_read_b64_tr_b16 a[244:245], v214 offset:200
    v_mfma_f32_16x16x32_bf16 v[48:51], a[248:251], a[16:19], v[48:51]
    ds_read_b64_tr_b16 a[246:247], v214 offset:456
    v_accvgpr_mov_b32 a58, a106
    v_mfma_f32_16x16x32_bf16 v[80:83], a[248:251], a[32:35], v[80:83]
    buffer_load_dwordx4 v210, s[20:23], s39 offen lds
    v_mfma_f32_16x16x32_bf16 v[112:115], a[248:251], a[48:51], v[112:115]
    s_add_u32 m0, s53, 144672
    s_add_u32 s39, s55, 128000
    v_accvgpr_mov_b32 a59, a107
    v_mfma_f32_16x16x32_bf16 v[144:147], a[248:251], a[64:67], v[144:147]
    buffer_load_dwordx4 v210, s[20:23], s39 offen lds
    v_mfma_f32_16x16x32_bf16 v[20:23], a[252:255], a[0:3], v[20:23]
    ds_read_b64_tr_b16 a[248:249], v214 offset:8448
    v_mfma_f32_16x16x32_bf16 v[52:55], a[252:255], a[16:19], v[52:55]
    ds_read_b64_tr_b16 a[250:251], v214 offset:8704
    v_accvgpr_mov_b32 a72, a112
    v_mfma_f32_16x16x32_bf16 v[84:87], a[252:255], a[32:35], v[84:87]
    s_add_u32 m0, s53, 152064
    s_add_u32 s39, s55, 163840
    v_mfma_f32_16x16x32_bf16 v[116:119], a[252:255], a[48:51], v[116:119]
    buffer_load_dwordx4 v210, s[20:23], s39 offen lds
    v_accvgpr_mov_b32 a73, a113
    v_mfma_f32_16x16x32_bf16 v[148:151], a[252:255], a[64:67], v[148:151]
    s_waitcnt lgkmcnt(2)
    v_mfma_f32_16x16x32_bf16 v[24:27], a[240:243], a[0:3], v[24:27]
    ds_read_b64_tr_b16 a[252:253], v214 offset:8456
    v_accvgpr_mov_b32 a74, a114
    v_mfma_f32_16x16x32_bf16 v[56:59], a[240:243], a[16:19], v[56:59]
    ds_read_b64_tr_b16 a[254:255], v214 offset:8712
    v_mfma_f32_16x16x32_bf16 v[88:91], a[240:243], a[32:35], v[88:91]
    s_add_u32 m0, s53, 153120
    s_add_u32 s39, s55, 168960
    v_accvgpr_mov_b32 a75, a115
    v_mfma_f32_16x16x32_bf16 v[120:123], a[240:243], a[48:51], v[120:123]
    buffer_load_dwordx4 v210, s[20:23], s39 offen lds
    v_mfma_f32_16x16x32_bf16 v[152:155], a[240:243], a[64:67], v[152:155]
    s_add_u32 m0, s52, 0
    s_add_u32 s39, s46, 0
    v_accvgpr_mov_b32 a12, a84
    v_mfma_f32_16x16x32_bf16 v[28:31], a[244:247], a[0:3], v[28:31]
    ds_read_b64_tr_b16 a[240:241], v214 offset:8512
    v_mfma_f32_16x16x32_bf16 v[60:63], a[244:247], a[16:19], v[60:63]
    ds_read_b64_tr_b16 a[242:243], v214 offset:8768
    v_accvgpr_mov_b32 a13, a85
    v_mfma_f32_16x16x32_bf16 v[92:95], a[244:247], a[32:35], v[92:95]
    buffer_load_dwordx4 v211, s[12:15], s39 offen lds
    v_mfma_f32_16x16x32_bf16 v[124:127], a[244:247], a[48:51], v[124:127]
    s_add_u32 m0, s52, 1056
    s_add_u32 s39, s46, 65536
    v_accvgpr_mov_b32 a14, a86
    v_mfma_f32_16x16x32_bf16 v[156:159], a[244:247], a[64:67], v[156:159]
    s_waitcnt lgkmcnt(2)
    v_mfma_f32_16x16x32_bf16 v[0:3], a[248:251], a[4:7], v[0:3]
    ds_read_b64_tr_b16 a[244:245], v214 offset:8520
    v_mfma_f32_16x16x32_bf16 v[32:35], a[248:251], a[20:23], v[32:35]
    ds_read_b64_tr_b16 a[246:247], v214 offset:8776
    v_accvgpr_mov_b32 a15, a87
    v_mfma_f32_16x16x32_bf16 v[64:67], a[248:251], a[36:39], v[64:67]
    buffer_load_dwordx4 v211, s[12:15], s39 offen lds
    v_mfma_f32_16x16x32_bf16 v[96:99], a[248:251], a[52:55], v[96:99]
    s_add_u32 m0, s52, 2112
    v_accvgpr_mov_b32 a28, a92
    v_mfma_f32_16x16x32_bf16 v[128:131], a[248:251], a[68:71], v[128:131]
    s_add_u32 s39, s46, 8192
    buffer_load_dwordx4 v211, s[12:15], s39 offen lds
    v_mfma_f32_16x16x32_bf16 v[4:7], a[252:255], a[4:7], v[4:7]
    ds_read_b64_tr_b16 a[248:249], v214 offset:8576
    v_accvgpr_mov_b32 a29, a93
    v_mfma_f32_16x16x32_bf16 v[36:39], a[252:255], a[20:23], v[36:39]
    ds_read_b64_tr_b16 a[250:251], v214 offset:8832
    v_mfma_f32_16x16x32_bf16 v[68:71], a[252:255], a[36:39], v[68:71]
    s_add_u32 m0, s52, 3168
    v_accvgpr_mov_b32 a30, a94
    v_mfma_f32_16x16x32_bf16 v[100:103], a[252:255], a[52:55], v[100:103]
    s_add_u32 s39, s46, 73728
    buffer_load_dwordx4 v211, s[12:15], s39 offen lds
    v_mfma_f32_16x16x32_bf16 v[132:135], a[252:255], a[68:71], v[132:135]
    s_waitcnt lgkmcnt(2)
    v_mfma_f32_16x16x32_bf16 v[8:11], a[240:243], a[4:7], v[8:11]
    ds_read_b64_tr_b16 a[252:253], v214 offset:8584
    v_accvgpr_mov_b32 a31, a95
    v_mfma_f32_16x16x32_bf16 v[40:43], a[240:243], a[20:23], v[40:43]
    ds_read_b64_tr_b16 a[254:255], v214 offset:8840
    v_mfma_f32_16x16x32_bf16 v[72:75], a[240:243], a[36:39], v[72:75]
    s_add_u32 m0, s52, 4224
    v_accvgpr_mov_b32 a44, a100
    v_mfma_f32_16x16x32_bf16 v[104:107], a[240:243], a[52:55], v[104:107]
    s_add_u32 s39, s46, 16384
    v_accvgpr_mov_b32 a45, a101
    v_mfma_f32_16x16x32_bf16 v[136:139], a[240:243], a[68:71], v[136:139]
    buffer_load_dwordx4 v211, s[12:15], s39 offen lds
    s_add_u32 m0, s52, 5280
    v_mfma_f32_16x16x32_bf16 v[12:15], a[244:247], a[4:7], v[12:15]
    ds_read_b64_tr_b16 a[240:241], v214 offset:8640
    v_accvgpr_mov_b32 a46, a102
    v_mfma_f32_16x16x32_bf16 v[44:47], a[244:247], a[20:23], v[44:47]
    ds_read_b64_tr_b16 a[242:243], v214 offset:8896
    v_mfma_f32_16x16x32_bf16 v[76:79], a[244:247], a[36:39], v[76:79]
    s_add_u32 s39, s46, 81920
    v_accvgpr_mov_b32 a47, a103
    v_mfma_f32_16x16x32_bf16 v[108:111], a[244:247], a[52:55], v[108:111]
    buffer_load_dwordx4 v211, s[12:15], s39 offen lds
    v_accvgpr_mov_b32 a60, a108
    v_mfma_f32_16x16x32_bf16 v[140:143], a[244:247], a[68:71], v[140:143]
    s_waitcnt lgkmcnt(2)
    v_mfma_f32_16x16x32_bf16 v[16:19], a[248:251], a[4:7], v[16:19]
    ds_read_b64_tr_b16 a[244:245], v214 offset:8648
    v_mfma_f32_16x16x32_bf16 v[48:51], a[248:251], a[20:23], v[48:51]
    ds_read_b64_tr_b16 a[246:247], v214 offset:8904
    v_accvgpr_mov_b32 a61, a109
    v_mfma_f32_16x16x32_bf16 v[80:83], a[248:251], a[36:39], v[80:83]
    s_add_u32 m0, s52, 6336
    s_add_u32 s39, s46, 24576
    v_mfma_f32_16x16x32_bf16 v[112:115], a[248:251], a[52:55], v[112:115]
    buffer_load_dwordx4 v211, s[12:15], s39 offen lds
    v_accvgpr_mov_b32 a62, a110
    v_mfma_f32_16x16x32_bf16 v[144:147], a[248:251], a[68:71], v[144:147]
    s_add_u32 m0, s52, 7392
    s_add_u32 s39, s46, 90112
    v_mfma_f32_16x16x32_bf16 v[20:23], a[252:255], a[4:7], v[20:23]
    buffer_load_dwordx4 v211, s[12:15], s39 offen lds
    v_accvgpr_mov_b32 a63, a111
    v_mfma_f32_16x16x32_bf16 v[52:55], a[252:255], a[20:23], v[52:55]
    v_accvgpr_mov_b32 a76, a116
    v_mfma_f32_16x16x32_bf16 v[84:87], a[252:255], a[36:39], v[84:87]
    v_accvgpr_mov_b32 a77, a117
    v_accvgpr_mov_b32 a78, a118
    v_mfma_f32_16x16x32_bf16 v[116:119], a[252:255], a[52:55], v[116:119]
    v_accvgpr_mov_b32 a79, a119
    v_mfma_f32_16x16x32_bf16 v[148:151], a[252:255], a[68:71], v[148:151]
    s_waitcnt vmcnt(8) lgkmcnt(0)
    s_barrier
    v_mfma_f32_16x16x32_bf16 v[24:27], a[240:243], a[4:7], v[24:27]
    ds_read_b64_tr_b16 a[248:249], v215 offset:0
    ds_read_b64_tr_b16 a[250:251], v215 offset:256
    v_mfma_f32_16x16x32_bf16 v[56:59], a[240:243], a[20:23], v[56:59]
    ds_read_b64_tr_b16 a[252:253], v215 offset:8
    ds_read_b64_tr_b16 a[254:255], v215 offset:264
    v_mfma_f32_16x16x32_bf16 v[88:91], a[240:243], a[36:39], v[88:91]
    s_add_u32 m0, s43, 0
    ds_read_b128 a[80:83], v212 offset:128
    v_accvgpr_write_b32 a120, v160
    v_mfma_f32_16x16x32_bf16 v[120:123], a[240:243], a[52:55], v[120:123]
    s_add_u32 s39, s46, 524288
    v_accvgpr_write_b32 a121, v161
    v_mfma_f32_16x16x32_bf16 v[152:155], a[240:243], a[68:71], v[152:155]
    ds_read_b128 a[88:91], v213 offset:128
    v_accvgpr_write_b32 a122, v162
    v_mfma_f32_16x16x32_bf16 v[28:31], a[244:247], a[4:7], v[28:31]
    ds_read_b64_tr_b16 a[240:241], v215 offset:64
    v_accvgpr_write_b32 a123, v163
    v_mfma_f32_16x16x32_bf16 v[60:63], a[244:247], a[20:23], v[60:63]
    ds_read_b64_tr_b16 a[242:243], v215 offset:320
    buffer_load_dwordx4 v[160:163], v221, s[8:11], 0 offen offset:0 nt
    v_mfma_f32_16x16x32_bf16 v[92:95], a[244:247], a[36:39], v[92:95]
    buffer_load_dwordx4 v211, s[12:15], s39 offen lds
    v_mfma_f32_16x16x32_bf16 v[124:127], a[244:247], a[52:55], v[124:127]
    ds_read_b128 a[96:99], v212 offset:8576
    v_accvgpr_write_b32 a124, v164
    v_mfma_f32_16x16x32_bf16 v[156:159], a[244:247], a[68:71], v[156:159]
    v_accvgpr_write_b32 a125, v165
    s_waitcnt lgkmcnt(7)
    v_mfma_f32_16x16x32_bf16 v[0:3], a[248:251], a[8:11], v[0:3]
    ds_read_b64_tr_b16 a[244:245], v215 offset:72
    v_accvgpr_write_b32 a126, v166
    v_mfma_f32_16x16x32_bf16 v[32:35], a[248:251], a[24:27], v[32:35]
    ds_read_b64_tr_b16 a[246:247], v215 offset:328
    v_accvgpr_write_b32 a127, v167
    v_mfma_f32_16x16x32_bf16 v[64:67], a[248:251], a[40:43], v[64:67]
    s_add_u32 m0, s43, 1056
    ds_read_b128 a[104:107], v213 offset:8576
    buffer_load_dwordx4 v[164:167], v221, s[8:11], 0 offen offset:1024 nt
    v_mfma_f32_16x16x32_bf16 v[96:99], a[248:251], a[56:59], v[96:99]
    s_add_u32 s39, s46, 589824
    v_accvgpr_write_b32 a128, v168
    v_mfma_f32_16x16x32_bf16 v[128:131], a[248:251], a[72:75], v[128:131]
    v_accvgpr_write_b32 a129, v169
    s_waitcnt lgkmcnt(8)
    v_mfma_f32_16x16x32_bf16 v[4:7], a[252:255], a[8:11], v[4:7]
    ds_read_b64_tr_b16 a[248:249], v215 offset:128
    v_accvgpr_write_b32 a130, v170
    v_mfma_f32_16x16x32_bf16 v[36:39], a[252:255], a[24:27], v[36:39]
    ds_read_b64_tr_b16 a[250:251], v215 offset:384
    v_accvgpr_write_b32 a131, v171
    v_mfma_f32_16x16x32_bf16 v[68:71], a[252:255], a[40:43], v[68:71]
    ds_read_b128 a[112:115], v212 offset:17024
    buffer_load_dwordx4 v[168:171], v221, s[8:11], 0 offen offset:2048 nt
    v_mfma_f32_16x16x32_bf16 v[100:103], a[252:255], a[56:59], v[100:103]
    buffer_load_dwordx4 v211, s[12:15], s39 offen lds
    v_mfma_f32_16x16x32_bf16 v[132:135], a[252:255], a[72:75], v[132:135]
    v_accvgpr_write_b32 a132, v172
    s_waitcnt lgkmcnt(4)
    v_mfma_f32_16x16x32_bf16 v[8:11], a[240:243], a[8:11], v[8:11]
    ds_read_b64_tr_b16 a[252:253], v215 offset:136
    v_accvgpr_write_b32 a133, v173
    v_mfma_f32_16x16x32_bf16 v[40:43], a[240:243], a[24:27], v[40:43]
    ds_read_b64_tr_b16 a[254:255], v215 offset:392
    v_accvgpr_write_b32 a134, v174
    v_mfma_f32_16x16x32_bf16 v[72:75], a[240:243], a[40:43], v[72:75]
    ds_read_b128 a[84:87], v212 offset:192
    v_accvgpr_write_b32 a135, v175
    v_mfma_f32_16x16x32_bf16 v[104:107], a[240:243], a[56:59], v[104:107]
    s_add_u32 m0, s43, 2112
    ds_read_b128 a[92:95], v213 offset:192
    v_mfma_f32_16x16x32_bf16 v[136:139], a[240:243], a[72:75], v[136:139]
    s_add_u32 s39, s46, 532480
    buffer_load_dwordx4 v[172:175], v221, s[8:11], 0 offen offset:3072 nt
    v_accvgpr_write_b32 a136, v176
    v_mfma_f32_16x16x32_bf16 v[12:15], a[244:247], a[8:11], v[12:15]
    ds_read_b64_tr_b16 a[240:241], v215 offset:192
    v_accvgpr_write_b32 a137, v177
    v_mfma_f32_16x16x32_bf16 v[44:47], a[244:247], a[24:27], v[44:47]
    ds_read_b64_tr_b16 a[242:243], v215 offset:448
    v_accvgpr_write_b32 a138, v178
    v_mfma_f32_16x16x32_bf16 v[76:79], a[244:247], a[40:43], v[76:79]
    buffer_load_dwordx4 v211, s[12:15], s39 offen lds
    v_accvgpr_write_b32 a139, v179
    v_mfma_f32_16x16x32_bf16 v[108:111], a[244:247], a[56:59], v[108:111]
    ds_read_b128 a[100:103], v212 offset:8640
    v_mfma_f32_16x16x32_bf16 v[140:143], a[244:247], a[72:75], v[140:143]
    buffer_load_dwordx4 v[176:179], v221, s[8:11], s58 offen offset:0 nt
    s_waitcnt lgkmcnt(5)
    v_mfma_f32_16x16x32_bf16 v[16:19], a[248:251], a[8:11], v[16:19]
    ds_read_b64_tr_b16 a[244:245], v215 offset:200
    v_accvgpr_write_b32 a140, v180
    v_mfma_f32_16x16x32_bf16 v[48:51], a[248:251], a[24:27], v[48:51]
    ds_read_b64_tr_b16 a[246:247], v215 offset:456
    v_accvgpr_write_b32 a141, v181
    v_mfma_f32_16x16x32_bf16 v[80:83], a[248:251], a[40:43], v[80:83]
    s_add_u32 m0, s43, 3168
    ds_read_b128 a[108:111], v213 offset:8640
    v_accvgpr_write_b32 a142, v182
    v_mfma_f32_16x16x32_bf16 v[112:115], a[248:251], a[56:59], v[112:115]
    s_add_u32 s39, s46, 598016
    v_accvgpr_write_b32 a143, v183
    v_mfma_f32_16x16x32_bf16 v[144:147], a[248:251], a[72:75], v[144:147]
    ds_read_b128 a[116:119], v212 offset:17088
    buffer_load_dwordx4 v[180:183], v221, s[8:11], s58 offen offset:1024 nt
    v_mfma_f32_16x16x32_bf16 v[20:23], a[252:255], a[8:11], v[20:23]
    ds_read_b64_tr_b16 a[248:249], v215 offset:8448
    v_accvgpr_write_b32 a144, v184
    v_mfma_f32_16x16x32_bf16 v[52:55], a[252:255], a[24:27], v[52:55]
    ds_read_b64_tr_b16 a[250:251], v215 offset:8704
    v_mfma_f32_16x16x32_bf16 v[84:87], a[252:255], a[40:43], v[84:87]
    buffer_load_dwordx4 v211, s[12:15], s39 offen lds
    v_accvgpr_write_b32 a145, v185
    v_mfma_f32_16x16x32_bf16 v[116:119], a[252:255], a[56:59], v[116:119]
    ds_read_b128 a[0:3], v212 offset:0
    v_accvgpr_write_b32 a146, v186
    v_mfma_f32_16x16x32_bf16 v[148:151], a[252:255], a[72:75], v[148:151]
    v_accvgpr_write_b32 a147, v187
    s_waitcnt lgkmcnt(5)
    v_mfma_f32_16x16x32_bf16 v[24:27], a[240:243], a[8:11], v[24:27]
    ds_read_b64_tr_b16 a[252:253], v215 offset:8456
    buffer_load_dwordx4 v[184:187], v221, s[8:11], s58 offen offset:2048 nt
    v_mfma_f32_16x16x32_bf16 v[56:59], a[240:243], a[24:27], v[56:59]
    ds_read_b64_tr_b16 a[254:255], v215 offset:8712
    v_accvgpr_write_b32 a148, v188
    v_mfma_f32_16x16x32_bf16 v[88:91], a[240:243], a[40:43], v[88:91]
    s_add_u32 m0, s43, 4224
    ds_read_b128 a[16:19], v213 offset:0
    v_mfma_f32_16x16x32_bf16 v[120:123], a[240:243], a[56:59], v[120:123]
    s_add_u32 s39, s46, 540672
    v_accvgpr_write_b32 a149, v189
    v_accvgpr_write_b32 a150, v190
    v_mfma_f32_16x16x32_bf16 v[152:155], a[240:243], a[72:75], v[152:155]
    ds_read_b128 a[32:35], v212 offset:8448
    v_accvgpr_write_b32 a151, v191
    v_mfma_f32_16x16x32_bf16 v[28:31], a[244:247], a[8:11], v[28:31]
    ds_read_b64_tr_b16 a[240:241], v215 offset:8512
    buffer_load_dwordx4 v[188:191], v221, s[8:11], s58 offen offset:3072 nt
    v_mfma_f32_16x16x32_bf16 v[60:63], a[244:247], a[24:27], v[60:63]
    ds_read_b64_tr_b16 a[242:243], v215 offset:8768
    v_mfma_f32_16x16x32_bf16 v[92:95], a[244:247], a[40:43], v[92:95]
    buffer_load_dwordx4 v211, s[12:15], s39 offen lds
    v_accvgpr_write_b32 a152, v192
    v_mfma_f32_16x16x32_bf16 v[124:127], a[244:247], a[56:59], v[124:127]
    ds_read_b128 a[48:51], v213 offset:8448
    v_accvgpr_write_b32 a153, v193
    v_mfma_f32_16x16x32_bf16 v[156:159], a[244:247], a[72:75], v[156:159]
    v_accvgpr_write_b32 a154, v194
    s_waitcnt lgkmcnt(5)
    v_mfma_f32_16x16x32_bf16 v[0:3], a[248:251], a[12:15], v[0:3]
    ds_read_b64_tr_b16 a[244:245], v215 offset:8520
    v_accvgpr_write_b32 a155, v195
    v_mfma_f32_16x16x32_bf16 v[32:35], a[248:251], a[28:31], v[32:35]
    ds_read_b64_tr_b16 a[246:247], v215 offset:8776
    buffer_load_dwordx4 v[192:195], v247, s[4:7], 0 offen offset:0 nt
    v_mfma_f32_16x16x32_bf16 v[64:67], a[248:251], a[44:47], v[64:67]
    s_add_u32 m0, s43, 5280
    ds_read_b128 a[64:67], v212 offset:16896
    v_mfma_f32_16x16x32_bf16 v[96:99], a[248:251], a[60:63], v[96:99]
    s_add_u32 s39, s46, 606208
    v_accvgpr_write_b32 a156, v196
    v_accvgpr_write_b32 a157, v197
    v_mfma_f32_16x16x32_bf16 v[128:131], a[248:251], a[76:79], v[128:131]
    ds_read_b128 a[4:7], v212 offset:64
    v_accvgpr_write_b32 a158, v198
    v_mfma_f32_16x16x32_bf16 v[4:7], a[252:255], a[12:15], v[4:7]
    ds_read_b64_tr_b16 a[248:249], v215 offset:8576
    v_accvgpr_write_b32 a159, v199
    v_mfma_f32_16x16x32_bf16 v[36:39], a[252:255], a[28:31], v[36:39]
    ds_read_b64_tr_b16 a[250:251], v215 offset:8832
    v_mfma_f32_16x16x32_bf16 v[68:71], a[252:255], a[44:47], v[68:71]
    buffer_load_dwordx4 v211, s[12:15], s39 offen lds
    buffer_load_dwordx4 v[196:199], v247, s[4:7], 0 offen offset:1024 nt
    v_mfma_f32_16x16x32_bf16 v[100:103], a[252:255], a[60:63], v[100:103]
    ds_read_b128 a[20:23], v213 offset:64
    v_xor_b32 v221, 0x4000, v221
    v_mfma_f32_16x16x32_bf16 v[132:135], a[252:255], a[76:79], v[132:135]
    v_add_u32 v247, 0x800, v247
    s_waitcnt lgkmcnt(5)
    v_mfma_f32_16x16x32_bf16 v[8:11], a[240:243], a[12:15], v[8:11]
    ds_read_b64_tr_b16 a[252:253], v215 offset:8584
    v_mfma_f32_16x16x32_bf16 v[40:43], a[240:243], a[28:31], v[40:43]
    ds_read_b64_tr_b16 a[254:255], v215 offset:8840
    v_mfma_f32_16x16x32_bf16 v[72:75], a[240:243], a[44:47], v[72:75]
    s_add_u32 m0, s43, 6336
    ds_read_b128 a[36:39], v212 offset:8512
    v_mfma_f32_16x16x32_bf16 v[104:107], a[240:243], a[60:63], v[104:107]
    s_add_u32 s39, s46, 548864
    v_mfma_f32_16x16x32_bf16 v[136:139], a[240:243], a[76:79], v[136:139]
    buffer_load_dwordx4 v211, s[12:15], s39 offen lds
    v_mfma_f32_16x16x32_bf16 v[12:15], a[244:247], a[12:15], v[12:15]
    ds_read_b64_tr_b16 a[240:241], v215 offset:8640
    v_mfma_f32_16x16x32_bf16 v[44:47], a[244:247], a[28:31], v[44:47]
    ds_read_b64_tr_b16 a[242:243], v215 offset:8896
    v_mfma_f32_16x16x32_bf16 v[76:79], a[244:247], a[44:47], v[76:79]
    ds_read_b128 a[52:55], v213 offset:8512
    v_mfma_f32_16x16x32_bf16 v[108:111], a[244:247], a[60:63], v[108:111]
    s_add_u32 m0, s43, 7392
    ds_read_b128 a[68:71], v212 offset:16960
    v_mfma_f32_16x16x32_bf16 v[140:143], a[244:247], a[76:79], v[140:143]
    s_waitcnt lgkmcnt(5)
    v_mfma_f32_16x16x32_bf16 v[16:19], a[248:251], a[12:15], v[16:19]
    ds_read_b64_tr_b16 a[244:245], v215 offset:8648
    v_mfma_f32_16x16x32_bf16 v[48:51], a[248:251], a[28:31], v[48:51]
    ds_read_b64_tr_b16 a[246:247], v215 offset:8904
    v_mfma_f32_16x16x32_bf16 v[80:83], a[248:251], a[44:47], v[80:83]
    s_add_u32 s39, s46, 614400
    v_mfma_f32_16x16x32_bf16 v[112:115], a[248:251], a[60:63], v[112:115]
    v_mfma_f32_16x16x32_bf16 v[144:147], a[248:251], a[76:79], v[144:147]
    buffer_load_dwordx4 v211, s[12:15], s39 offen lds
    v_mfma_f32_16x16x32_bf16 v[20:23], a[252:255], a[12:15], v[20:23]
    v_mfma_f32_16x16x32_bf16 v[52:55], a[252:255], a[28:31], v[52:55]
    v_mfma_f32_16x16x32_bf16 v[84:87], a[252:255], a[44:47], v[84:87]
    v_mfma_f32_16x16x32_bf16 v[116:119], a[252:255], a[60:63], v[116:119]
    v_mfma_f32_16x16x32_bf16 v[148:151], a[252:255], a[76:79], v[148:151]
    v_mov_b32 v251, v216
    v_mov_b32 v216, v215
    v_mov_b32 v215, v214
    v_mov_b32 v214, v251
    s_mov_b32 s39, s52
    s_mov_b32 s52, s49
    s_mov_b32 s49, s48
    s_mov_b32 s48, s39
    s_add_u32 s31, s31, 1
    s_cmp_lt_u32 s31, 4
    s_waitcnt vmcnt(18) lgkmcnt(0)
    s_barrier
    s_cbranch_scc1 L_Q_loop
    s_add_u32 s43, s37, 118272
    s_mul_i32 s39, s42, 16896
    s_add_u32 s39, s39, 118272
    v_add_u32 v215, s39, v217
    v_add_u32 v218, s33, v204
    v_add_u32 v220, s32, v204
    v_xor_b32 v209, 0x8000, v209
    v_mov_b32 v221, 2146435072
    v_mfma_f32_16x16x32_bf16 v[24:27], a[240:243], a[12:15], v[24:27]
    ds_read_b64_tr_b16 a[248:249], v214 offset:0
    ds_read_b64_tr_b16 a[250:251], v214 offset:256
    v_mfma_f32_16x16x32_bf16 v[56:59], a[240:243], a[28:31], v[56:59]
    ds_read_b64_tr_b16 a[252:253], v214 offset:8
    ds_read_b64_tr_b16 a[254:255], v214 offset:264
    v_mfma_f32_16x16x32_bf16 v[88:91], a[240:243], a[44:47], v[88:91]
    s_add_u32 m0, s43, 0
    s_add_u32 s39, s46, 524288
    v_accvgpr_mov_b32 a8, a80
    v_mfma_f32_16x16x32_bf16 v[120:123], a[240:243], a[60:63], v[120:123]
    buffer_load_dwordx4 v211, s[12:15], s39 offen lds
    v_mfma_f32_16x16x32_bf16 v[152:155], a[240:243], a[76:79], v[152:155]
    s_add_u32 m0, s43, 1056
    v_accvgpr_mov_b32 a9, a81
    v_mfma_f32_16x16x32_bf16 v[28:31], a[244:247], a[12:15], v[28:31]
    ds_read_b64_tr_b16 a[240:241], v214 offset:64
    v_mfma_f32_16x16x32_bf16 v[60:63], a[244:247], a[28:31], v[60:63]
    ds_read_b64_tr_b16 a[242:243], v214 offset:320
    v_accvgpr_mov_b32 a10, a82
    v_mfma_f32_16x16x32_bf16 v[92:95], a[244:247], a[44:47], v[92:95]
    s_add_u32 s39, s46, 589824
    v_mfma_f32_16x16x32_bf16 v[124:127], a[244:247], a[60:63], v[124:127]
    buffer_load_dwordx4 v211, s[12:15], s39 offen lds
    v_accvgpr_mov_b32 a11, a83
    v_mfma_f32_16x16x32_bf16 v[156:159], a[244:247], a[76:79], v[156:159]
    s_waitcnt lgkmcnt(4)
    v_mfma_f32_16x16x32_bf16 v[0:3], a[248:251], a[0:3], v[0:3]
    ds_read_b64_tr_b16 a[244:245], v214 offset:72
    v_mfma_f32_16x16x32_bf16 v[32:35], a[248:251], a[16:19], v[32:35]
    ds_read_b64_tr_b16 a[246:247], v214 offset:328
    v_accvgpr_mov_b32 a24, a88
    v_mfma_f32_16x16x32_bf16 v[64:67], a[248:251], a[32:35], v[64:67]
    s_add_u32 m0, s43, 2112
    s_add_u32 s39, s46, 532480
    v_mfma_f32_16x16x32_bf16 v[96:99], a[248:251], a[48:51], v[96:99]
    buffer_load_dwordx4 v211, s[12:15], s39 offen lds
    v_accvgpr_mov_b32 a25, a89
    v_mfma_f32_16x16x32_bf16 v[128:131], a[248:251], a[64:67], v[128:131]
    s_waitcnt lgkmcnt(4)
    v_mfma_f32_16x16x32_bf16 v[4:7], a[252:255], a[0:3], v[4:7]
    ds_read_b64_tr_b16 a[248:249], v214 offset:128
    v_mfma_f32_16x16x32_bf16 v[36:39], a[252:255], a[16:19], v[36:39]
    ds_read_b64_tr_b16 a[250:251], v214 offset:384
    v_accvgpr_mov_b32 a26, a90
    v_mfma_f32_16x16x32_bf16 v[68:71], a[252:255], a[32:35], v[68:71]
    s_add_u32 m0, s43, 3168
    v_accvgpr_mov_b32 a27, a91
    v_mfma_f32_16x16x32_bf16 v[100:103], a[252:255], a[48:51], v[100:103]
    s_add_u32 s39, s46, 598016
    v_accvgpr_mov_b32 a40, a96
    v_mfma_f32_16x16x32_bf16 v[132:135], a[252:255], a[64:67], v[132:135]
    s_waitcnt lgkmcnt(2)
    v_mfma_f32_16x16x32_bf16 v[8:11], a[240:243], a[0:3], v[8:11]
    ds_read_b64_tr_b16 a[252:253], v214 offset:136
    v_mfma_f32_16x16x32_bf16 v[40:43], a[240:243], a[16:19], v[40:43]
    ds_read_b64_tr_b16 a[254:255], v214 offset:392
    v_accvgpr_mov_b32 a41, a97
    v_mfma_f32_16x16x32_bf16 v[72:75], a[240:243], a[32:35], v[72:75]
    buffer_load_dwordx4 v211, s[12:15], s39 offen lds
    v_mfma_f32_16x16x32_bf16 v[104:107], a[240:243], a[48:51], v[104:107]
    s_add_u32 m0, s43, 4224
    s_add_u32 s39, s46, 540672
    v_accvgpr_mov_b32 a42, a98
    v_mfma_f32_16x16x32_bf16 v[136:139], a[240:243], a[64:67], v[136:139]
    buffer_load_dwordx4 v211, s[12:15], s39 offen lds
    v_mfma_f32_16x16x32_bf16 v[12:15], a[244:247], a[0:3], v[12:15]
    ds_read_b64_tr_b16 a[240:241], v214 offset:192
    v_mfma_f32_16x16x32_bf16 v[44:47], a[244:247], a[16:19], v[44:47]
    ds_read_b64_tr_b16 a[242:243], v214 offset:448
    v_accvgpr_mov_b32 a43, a99
    v_mfma_f32_16x16x32_bf16 v[76:79], a[244:247], a[32:35], v[76:79]
    s_add_u32 m0, s43, 5280
    v_accvgpr_mov_b32 a56, a104
    v_mfma_f32_16x16x32_bf16 v[108:111], a[244:247], a[48:51], v[108:111]
    s_add_u32 s39, s46, 606208
    v_mfma_f32_16x16x32_bf16 v[140:143], a[244:247], a[64:67], v[140:143]
    v_accvgpr_mov_b32 a57, a105
    s_waitcnt lgkmcnt(2)
    v_mfma_f32_16x16x32_bf16 v[16:19], a[248:251], a[0:3], v[16:19]
    ds_read_b64_tr_b16 a[244:245], v214 offset:200
    v_mfma_f32_16x16x32_bf16 v[48:51], a[248:251], a[16:19], v[48:51]
    ds_read_b64_tr_b16 a[246:247], v214 offset:456
    v_accvgpr_mov_b32 a58, a106
    v_mfma_f32_16x16x32_bf16 v[80:83], a[248:251], a[32:35], v[80:83]
    buffer_load_dwordx4 v211, s[12:15], s39 offen lds
    v_mfma_f32_16x16x32_bf16 v[112:115], a[248:251], a[48:51], v[112:115]
    s_add_u32 m0, s43, 6336
    s_add_u32 s39, s46, 548864
    v_mfma_f32_16x16x32_bf16 v[144:147], a[248:251], a[64:67], v[144:147]
    buffer_load_dwordx4 v211, s[12:15], s39 offen lds
    v_accvgpr_mov_b32 a59, a107
    v_mfma_f32_16x16x32_bf16 v[20:23], a[252:255], a[0:3], v[20:23]
    ds_read_b64_tr_b16 a[248:249], v214 offset:8448
    v_mfma_f32_16x16x32_bf16 v[52:55], a[252:255], a[16:19], v[52:55]
    ds_read_b64_tr_b16 a[250:251], v214 offset:8704
    v_mfma_f32_16x16x32_bf16 v[84:87], a[252:255], a[32:35], v[84:87]
    s_add_u32 m0, s43, 7392
    v_accvgpr_mov_b32 a72, a112
    v_mfma_f32_16x16x32_bf16 v[116:119], a[252:255], a[48:51], v[116:119]
    s_add_u32 s39, s46, 614400
    v_accvgpr_mov_b32 a73, a113
    v_mfma_f32_16x16x32_bf16 v[148:151], a[252:255], a[64:67], v[148:151]
    v_accvgpr_mov_b32 a74, a114
    s_waitcnt lgkmcnt(2)
    v_mfma_f32_16x16x32_bf16 v[24:27], a[240:243], a[0:3], v[24:27]
    ds_read_b64_tr_b16 a[252:253], v214 offset:8456
    v_mfma_f32_16x16x32_bf16 v[56:59], a[240:243], a[16:19], v[56:59]
    ds_read_b64_tr_b16 a[254:255], v214 offset:8712
    v_mfma_f32_16x16x32_bf16 v[88:91], a[240:243], a[32:35], v[88:91]
    buffer_load_dwordx4 v211, s[12:15], s39 offen lds
    v_accvgpr_mov_b32 a75, a115
    v_mfma_f32_16x16x32_bf16 v[120:123], a[240:243], a[48:51], v[120:123]
    s_add_u32 m0, s32, 0
    v_accvgpr_mov_b32 a12, a84
    v_mfma_f32_16x16x32_bf16 v[152:155], a[240:243], a[64:67], v[152:155]
    buffer_load_dwordx4 v208, s[4:7], 0 offen offset:0 nt lds
    v_mfma_f32_16x16x32_bf16 v[28:31], a[244:247], a[0:3], v[28:31]
    ds_read_b64_tr_b16 a[240:241], v214 offset:8512
    v_mfma_f32_16x16x32_bf16 v[60:63], a[244:247], a[16:19], v[60:63]
    ds_read_b64_tr_b16 a[242:243], v214 offset:8768
    v_accvgpr_mov_b32 a13, a85
    v_mfma_f32_16x16x32_bf16 v[92:95], a[244:247], a[32:35], v[92:95]
    s_add_u32 m0, s32, 32
    s_nop 0
    buffer_load_dwordx4 v208, s[4:7], 0 offen offset:1024 nt lds
    v_mfma_f32_16x16x32_bf16 v[124:127], a[244:247], a[48:51], v[124:127]
    s_add_u32 m0, s32, 64
    v_accvgpr_mov_b32 a14, a86
    v_mfma_f32_16x16x32_bf16 v[156:159], a[244:247], a[64:67], v[156:159]
    s_waitcnt lgkmcnt(2)
    v_mfma_f32_16x16x32_bf16 v[0:3], a[248:251], a[4:7], v[0:3]
    ds_read_b64_tr_b16 a[244:245], v214 offset:8520
    v_mfma_f32_16x16x32_bf16 v[32:35], a[248:251], a[20:23], v[32:35]
    ds_read_b64_tr_b16 a[246:247], v214 offset:8776
    v_accvgpr_mov_b32 a15, a87
    v_mfma_f32_16x16x32_bf16 v[64:67], a[248:251], a[36:39], v[64:67]
    buffer_load_dwordx4 v208, s[4:7], 0 offen offset:2048 nt lds
    v_mfma_f32_16x16x32_bf16 v[96:99], a[248:251], a[52:55], v[96:99]
    s_add_u32 m0, s32, 96
    v_accvgpr_mov_b32 a28, a92
    v_mfma_f32_16x16x32_bf16 v[128:131], a[248:251], a[68:71], v[128:131]
    buffer_load_dwordx4 v208, s[4:7], 0 offen offset:3072 nt lds
    v_mfma_f32_16x16x32_bf16 v[4:7], a[252:255], a[4:7], v[4:7]
    ds_read_b64_tr_b16 a[248:249], v214 offset:8576
    v_accvgpr_mov_b32 a29, a93
    v_mfma_f32_16x16x32_bf16 v[36:39], a[252:255], a[20:23], v[36:39]
    ds_read_b64_tr_b16 a[250:251], v214 offset:8832
    v_mfma_f32_16x16x32_bf16 v[68:71], a[252:255], a[36:39], v[68:71]
    v_accvgpr_mov_b32 a30, a94
    v_mfma_f32_16x16x32_bf16 v[100:103], a[252:255], a[52:55], v[100:103]
    v_add_u32 v208, s58, v208
    v_accvgpr_mov_b32 a31, a95
    v_mfma_f32_16x16x32_bf16 v[132:135], a[252:255], a[68:71], v[132:135]
    s_waitcnt lgkmcnt(2)
    v_mfma_f32_16x16x32_bf16 v[8:11], a[240:243], a[4:7], v[8:11]
    ds_read_b64_tr_b16 a[252:253], v214 offset:8584
    v_mfma_f32_16x16x32_bf16 v[40:43], a[240:243], a[20:23], v[40:43]
    ds_read_b64_tr_b16 a[254:255], v214 offset:8840
    v_accvgpr_mov_b32 a44, a100
    v_mfma_f32_16x16x32_bf16 v[72:75], a[240:243], a[36:39], v[72:75]
    s_add_u32 m0, s32, 8448
    v_accvgpr_mov_b32 a45, a101
    v_mfma_f32_16x16x32_bf16 v[104:107], a[240:243], a[52:55], v[104:107]
    buffer_load_dwordx4 v208, s[4:7], 0 offen offset:0 nt lds
    v_mfma_f32_16x16x32_bf16 v[136:139], a[240:243], a[68:71], v[136:139]
    s_add_u32 m0, s32, 8480
    v_accvgpr_mov_b32 a46, a102
    v_mfma_f32_16x16x32_bf16 v[12:15], a[244:247], a[4:7], v[12:15]
    ds_read_b64_tr_b16 a[240:241], v214 offset:8640
    v_mfma_f32_16x16x32_bf16 v[44:47], a[244:247], a[20:23], v[44:47]
    ds_read_b64_tr_b16 a[242:243], v214 offset:8896
    v_accvgpr_mov_b32 a47, a103
    v_mfma_f32_16x16x32_bf16 v[76:79], a[244:247], a[36:39], v[76:79]
    buffer_load_dwordx4 v208, s[4:7], 0 offen offset:1024 nt lds
    v_mfma_f32_16x16x32_bf16 v[108:111], a[244:247], a[52:55], v[108:111]
    s_add_u32 m0, s32, 8512
    v_accvgpr_mov_b32 a60, a108
    v_mfma_f32_16x16x32_bf16 v[140:143], a[244:247], a[68:71], v[140:143]
    s_waitcnt lgkmcnt(2)
    v_mfma_f32_16x16x32_bf16 v[16:19], a[248:251], a[4:7], v[16:19]
    ds_read_b64_tr_b16 a[244:245], v214 offset:8648
    v_accvgpr_mov_b32 a61, a109
    v_mfma_f32_16x16x32_bf16 v[48:51], a[248:251], a[20:23], v[48:51]
    ds_read_b64_tr_b16 a[246:247], v214 offset:8904
    v_mfma_f32_16x16x32_bf16 v[80:83], a[248:251], a[36:39], v[80:83]
    buffer_load_dwordx4 v208, s[4:7], 0 offen offset:2048 nt lds
    s_add_u32 m0, s32, 8544
    v_mfma_f32_16x16x32_bf16 v[112:115], a[248:251], a[52:55], v[112:115]
    buffer_load_dwordx4 v208, s[4:7], 0 offen offset:3072 nt lds
    v_mfma_f32_16x16x32_bf16 v[144:147], a[248:251], a[68:71], v[144:147]
    v_accvgpr_mov_b32 a62, a110
    v_accvgpr_mov_b32 a63, a111
    v_mfma_f32_16x16x32_bf16 v[20:23], a[252:255], a[4:7], v[20:23]
    v_add_u32 v208, s58, v208
    v_mfma_f32_16x16x32_bf16 v[52:55], a[252:255], a[20:23], v[52:55]
    v_accvgpr_mov_b32 a76, a116
    v_mfma_f32_16x16x32_bf16 v[84:87], a[252:255], a[36:39], v[84:87]
    v_accvgpr_mov_b32 a77, a117
    v_accvgpr_mov_b32 a78, a118
    v_mfma_f32_16x16x32_bf16 v[116:119], a[252:255], a[52:55], v[116:119]
    v_accvgpr_mov_b32 a79, a119
    v_mfma_f32_16x16x32_bf16 v[148:151], a[252:255], a[68:71], v[148:151]
    s_waitcnt vmcnt(8) lgkmcnt(0)
    s_barrier
    v_mfma_f32_16x16x32_bf16 v[24:27], a[240:243], a[4:7], v[24:27]
    ds_read_b64_tr_b16 a[248:249], v215 offset:0
    ds_read_b64_tr_b16 a[250:251], v215 offset:256
    v_mfma_f32_16x16x32_bf16 v[56:59], a[240:243], a[20:23], v[56:59]
    ds_read_b64_tr_b16 a[252:253], v215 offset:8
    ds_read_b64_tr_b16 a[254:255], v215 offset:264
    v_mfma_f32_16x16x32_bf16 v[88:91], a[240:243], a[36:39], v[88:91]
    s_add_u32 m0, s32, 16896
    v_mfma_f32_16x16x32_bf16 v[120:123], a[240:243], a[52:55], v[120:123]
    v_mfma_f32_16x16x32_bf16 v[152:155], a[240:243], a[68:71], v[152:155]
    v_mfma_f32_16x16x32_bf16 v[28:31], a[244:247], a[4:7], v[28:31]
    ds_read_b64_tr_b16 a[240:241], v215 offset:64
    v_mfma_f32_16x16x32_bf16 v[60:63], a[244:247], a[20:23], v[60:63]
    ds_read_b64_tr_b16 a[242:243], v215 offset:320
    v_mfma_f32_16x16x32_bf16 v[92:95], a[244:247], a[36:39], v[92:95]
    ds_write_b128 v220, a[152:155] offset:25344
    v_mfma_f32_16x16x32_bf16 v[124:127], a[244:247], a[52:55], v[124:127]
    buffer_load_dwordx4 v208, s[4:7], 0 offen offset:0 nt lds
    v_mfma_f32_16x16x32_bf16 v[156:159], a[244:247], a[68:71], v[156:159]
    s_waitcnt lgkmcnt(5)
    v_mfma_f32_16x16x32_bf16 v[0:3], a[248:251], a[8:11], v[0:3]
    ds_read_b64_tr_b16 a[244:245], v215 offset:72
    v_mfma_f32_16x16x32_bf16 v[32:35], a[248:251], a[24:27], v[32:35]
    ds_read_b64_tr_b16 a[246:247], v215 offset:328
    v_mfma_f32_16x16x32_bf16 v[64:67], a[248:251], a[40:43], v[64:67]
    v_mfma_f32_16x16x32_bf16 v[96:99], a[248:251], a[56:59], v[96:99]
    v_mfma_f32_16x16x32_bf16 v[128:131], a[248:251], a[72:75], v[128:131]
    s_waitcnt lgkmcnt(5)
    v_mfma_f32_16x16x32_bf16 v[4:7], a[252:255], a[8:11], v[4:7]
    ds_read_b64_tr_b16 a[248:249], v215 offset:128
    v_mfma_f32_16x16x32_bf16 v[36:39], a[252:255], a[24:27], v[36:39]
    ds_read_b64_tr_b16 a[250:251], v215 offset:384
    v_mfma_f32_16x16x32_bf16 v[68:71], a[252:255], a[40:43], v[68:71]
    s_add_u32 m0, s32, 16928
    v_mfma_f32_16x16x32_bf16 v[100:103], a[252:255], a[56:59], v[100:103]
    v_mfma_f32_16x16x32_bf16 v[132:135], a[252:255], a[72:75], v[132:135]
    s_waitcnt lgkmcnt(2)
    v_mfma_f32_16x16x32_bf16 v[8:11], a[240:243], a[8:11], v[8:11]
    ds_read_b64_tr_b16 a[252:253], v215 offset:136
    v_mfma_f32_16x16x32_bf16 v[40:43], a[240:243], a[24:27], v[40:43]
    ds_read_b64_tr_b16 a[254:255], v215 offset:392
    v_mfma_f32_16x16x32_bf16 v[72:75], a[240:243], a[40:43], v[72:75]
    v_mfma_f32_16x16x32_bf16 v[104:107], a[240:243], a[56:59], v[104:107]
    ds_write_b128 v220, a[156:159] offset:26400
    v_mfma_f32_16x16x32_bf16 v[136:139], a[240:243], a[72:75], v[136:139]
    buffer_load_dwordx4 v208, s[4:7], 0 offen offset:1024 nt lds
    v_mfma_f32_16x16x32_bf16 v[12:15], a[244:247], a[8:11], v[12:15]
    ds_read_b64_tr_b16 a[240:241], v215 offset:192
    v_mfma_f32_16x16x32_bf16 v[44:47], a[244:247], a[24:27], v[44:47]
    ds_read_b64_tr_b16 a[242:243], v215 offset:448
    v_mfma_f32_16x16x32_bf16 v[76:79], a[244:247], a[40:43], v[76:79]
    v_mfma_f32_16x16x32_bf16 v[108:111], a[244:247], a[56:59], v[108:111]
    v_mfma_f32_16x16x32_bf16 v[140:143], a[244:247], a[72:75], v[140:143]
    s_waitcnt lgkmcnt(3)
    v_mfma_f32_16x16x32_bf16 v[16:19], a[248:251], a[8:11], v[16:19]
    ds_read_b64_tr_b16 a[244:245], v215 offset:200
    v_mfma_f32_16x16x32_bf16 v[48:51], a[248:251], a[24:27], v[48:51]
    ds_read_b64_tr_b16 a[246:247], v215 offset:456
    v_mfma_f32_16x16x32_bf16 v[80:83], a[248:251], a[40:43], v[80:83]
    s_add_u32 m0, s32, 16960
    v_mfma_f32_16x16x32_bf16 v[112:115], a[248:251], a[56:59], v[112:115]
    v_mfma_f32_16x16x32_bf16 v[144:147], a[248:251], a[72:75], v[144:147]
    v_mfma_f32_16x16x32_bf16 v[20:23], a[252:255], a[8:11], v[20:23]
    ds_read_b64_tr_b16 a[248:249], v215 offset:8448
    v_mfma_f32_16x16x32_bf16 v[52:55], a[252:255], a[24:27], v[52:55]
    ds_read_b64_tr_b16 a[250:251], v215 offset:8704
    v_mfma_f32_16x16x32_bf16 v[84:87], a[252:255], a[40:43], v[84:87]
    v_mfma_f32_16x16x32_bf16 v[116:119], a[252:255], a[56:59], v[116:119]
    buffer_load_dwordx4 v208, s[4:7], 0 offen offset:2048 nt lds
    v_mfma_f32_16x16x32_bf16 v[148:151], a[252:255], a[72:75], v[148:151]
    s_waitcnt lgkmcnt(2)
    v_mfma_f32_16x16x32_bf16 v[24:27], a[240:243], a[8:11], v[24:27]
    ds_read_b64_tr_b16 a[252:253], v215 offset:8456
    v_mfma_f32_16x16x32_bf16 v[56:59], a[240:243], a[24:27], v[56:59]
    ds_read_b64_tr_b16 a[254:255], v215 offset:8712
    v_mfma_f32_16x16x32_bf16 v[88:91], a[240:243], a[40:43], v[88:91]
    ds_write_b128 v220, v[192:195] offset:27456
    v_mfma_f32_16x16x32_bf16 v[120:123], a[240:243], a[56:59], v[120:123]
    v_mfma_f32_16x16x32_bf16 v[152:155], a[240:243], a[72:75], v[152:155]
    s_add_u32 m0, s32, 16992
    v_mfma_f32_16x16x32_bf16 v[28:31], a[244:247], a[8:11], v[28:31]
    ds_read_b64_tr_b16 a[240:241], v215 offset:8512
    v_mfma_f32_16x16x32_bf16 v[60:63], a[244:247], a[24:27], v[60:63]
    ds_read_b64_tr_b16 a[242:243], v215 offset:8768
    v_mfma_f32_16x16x32_bf16 v[92:95], a[244:247], a[40:43], v[92:95]
    v_mfma_f32_16x16x32_bf16 v[124:127], a[244:247], a[56:59], v[124:127]
    v_mfma_f32_16x16x32_bf16 v[156:159], a[244:247], a[72:75], v[156:159]
    s_waitcnt lgkmcnt(3)
    v_mfma_f32_16x16x32_bf16 v[0:3], a[248:251], a[12:15], v[0:3]
    ds_read_b64_tr_b16 a[244:245], v215 offset:8520
    v_mfma_f32_16x16x32_bf16 v[32:35], a[248:251], a[28:31], v[32:35]
    ds_read_b64_tr_b16 a[246:247], v215 offset:8776
    v_mfma_f32_16x16x32_bf16 v[64:67], a[248:251], a[44:47], v[64:67]
    v_mfma_f32_16x16x32_bf16 v[96:99], a[248:251], a[60:63], v[96:99]
    buffer_load_dwordx4 v208, s[4:7], 0 offen offset:3072 nt lds
    v_mfma_f32_16x16x32_bf16 v[128:131], a[248:251], a[76:79], v[128:131]
    ds_write_b128 v220, v[196:199] offset:28512
    v_mfma_f32_16x16x32_bf16 v[4:7], a[252:255], a[12:15], v[4:7]
    ds_read_b64_tr_b16 a[248:249], v215 offset:8576
    v_mfma_f32_16x16x32_bf16 v[36:39], a[252:255], a[28:31], v[36:39]
    ds_read_b64_tr_b16 a[250:251], v215 offset:8832
    v_mfma_f32_16x16x32_bf16 v[68:71], a[252:255], a[44:47], v[68:71]
    v_mfma_f32_16x16x32_bf16 v[100:103], a[252:255], a[60:63], v[100:103]
    v_mfma_f32_16x16x32_bf16 v[132:135], a[252:255], a[76:79], v[132:135]
    s_waitcnt lgkmcnt(3)
    v_mfma_f32_16x16x32_bf16 v[8:11], a[240:243], a[12:15], v[8:11]
    ds_read_b64_tr_b16 a[252:253], v215 offset:8584
    v_mfma_f32_16x16x32_bf16 v[40:43], a[240:243], a[28:31], v[40:43]
    ds_read_b64_tr_b16 a[254:255], v215 offset:8840
    v_mfma_f32_16x16x32_bf16 v[72:75], a[240:243], a[44:47], v[72:75]
    v_mfma_f32_16x16x32_bf16 v[104:107], a[240:243], a[60:63], v[104:107]
    v_add_u32 v208, s58, v208
    v_mfma_f32_16x16x32_bf16 v[136:139], a[240:243], a[76:79], v[136:139]
    v_mfma_f32_16x16x32_bf16 v[12:15], a[244:247], a[12:15], v[12:15]
    ds_read_b64_tr_b16 a[240:241], v215 offset:8640
    v_mfma_f32_16x16x32_bf16 v[44:47], a[244:247], a[28:31], v[44:47]
    ds_read_b64_tr_b16 a[242:243], v215 offset:8896
    v_mfma_f32_16x16x32_bf16 v[76:79], a[244:247], a[44:47], v[76:79]
    v_mfma_f32_16x16x32_bf16 v[108:111], a[244:247], a[60:63], v[108:111]
    v_mfma_f32_16x16x32_bf16 v[140:143], a[244:247], a[76:79], v[140:143]
    s_waitcnt lgkmcnt(2)
    v_mfma_f32_16x16x32_bf16 v[16:19], a[248:251], a[12:15], v[16:19]
    ds_read_b64_tr_b16 a[244:245], v215 offset:8648
    v_mfma_f32_16x16x32_bf16 v[48:51], a[248:251], a[28:31], v[48:51]
    ds_read_b64_tr_b16 a[246:247], v215 offset:8904
    v_mfma_f32_16x16x32_bf16 v[80:83], a[248:251], a[44:47], v[80:83]
    v_mfma_f32_16x16x32_bf16 v[112:115], a[248:251], a[60:63], v[112:115]
    v_add_u32 v208, s58, v208
    v_mfma_f32_16x16x32_bf16 v[144:147], a[248:251], a[76:79], v[144:147]
    v_mfma_f32_16x16x32_bf16 v[20:23], a[252:255], a[12:15], v[20:23]
    v_mfma_f32_16x16x32_bf16 v[52:55], a[252:255], a[28:31], v[52:55]
    v_mfma_f32_16x16x32_bf16 v[84:87], a[252:255], a[44:47], v[84:87]
    v_mfma_f32_16x16x32_bf16 v[116:119], a[252:255], a[60:63], v[116:119]
    v_mfma_f32_16x16x32_bf16 v[148:151], a[252:255], a[76:79], v[148:151]
    s_waitcnt vmcnt(8) lgkmcnt(0)
    s_barrier
    v_mfma_f32_16x16x32_bf16 v[24:27], a[240:243], a[12:15], v[24:27]
    v_mfma_f32_16x16x32_bf16 v[56:59], a[240:243], a[28:31], v[56:59]
    v_mfma_f32_16x16x32_bf16 v[88:91], a[240:243], a[44:47], v[88:91]
    v_mfma_f32_16x16x32_bf16 v[120:123], a[240:243], a[60:63], v[120:123]
    v_mfma_f32_16x16x32_bf16 v[152:155], a[240:243], a[76:79], v[152:155]
    v_mfma_f32_16x16x32_bf16 v[28:31], a[244:247], a[12:15], v[28:31]
    v_mfma_f32_16x16x32_bf16 v[60:63], a[244:247], a[28:31], v[60:63]
    v_mfma_f32_16x16x32_bf16 v[92:95], a[244:247], a[44:47], v[92:95]
    v_mfma_f32_16x16x32_bf16 v[124:127], a[244:247], a[60:63], v[124:127]
    v_mfma_f32_16x16x32_bf16 v[156:159], a[244:247], a[76:79], v[156:159]
    v_pk_mul_f32 v[0:1], v[0:1], s[40:41] op_sel_hi:[1,0]
    ds_write_b128 v218, a[120:123] offset:16896
    v_pk_mul_f32 v[2:3], v[2:3], s[40:41] op_sel_hi:[1,0]
    v_pk_mul_f32 v[4:5], v[4:5], s[40:41] op_sel_hi:[1,0]
    v_cvt_pk_bf16_f32 v0, v0, v1
    v_pk_mul_f32 v[6:7], v[6:7], s[40:41] op_sel_hi:[1,0]
    v_cvt_pk_bf16_f32 v1, v2, v3
    v_pk_mul_f32 v[8:9], v[8:9], s[40:41] op_sel_hi:[1,0]
    v_cvt_pk_bf16_f32 v2, v4, v5
    v_pk_mul_f32 v[10:11], v[10:11], s[40:41] op_sel_hi:[1,0]
    v_cvt_pk_bf16_f32 v3, v6, v7
    ds_write_b128 v218, a[124:127] offset:17952
    v_pk_mul_f32 v[12:13], v[12:13], s[40:41] op_sel_hi:[1,0]
    v_cvt_pk_bf16_f32 v4, v8, v9
    v_pk_mul_f32 v[14:15], v[14:15], s[40:41] op_sel_hi:[1,0]
    v_cvt_pk_bf16_f32 v5, v10, v11
    v_pk_mul_f32 v[16:17], v[16:17], s[40:41] op_sel_hi:[1,0]
    v_cvt_pk_bf16_f32 v6, v12, v13
    v_pk_mul_f32 v[18:19], v[18:19], s[40:41] op_sel_hi:[1,0]
    v_cvt_pk_bf16_f32 v7, v14, v15
    v_pk_mul_f32 v[20:21], v[20:21], s[40:41] op_sel_hi:[1,0]
    v_cvt_pk_bf16_f32 v8, v16, v17
    ds_write_b128 v218, a[128:131] offset:19008
    v_pk_mul_f32 v[22:23], v[22:23], s[40:41] op_sel_hi:[1,0]
    v_cvt_pk_bf16_f32 v9, v18, v19
    v_pk_mul_f32 v[24:25], v[24:25], s[40:41] op_sel_hi:[1,0]
    v_cvt_pk_bf16_f32 v10, v20, v21
    v_pk_mul_f32 v[26:27], v[26:27], s[40:41] op_sel_hi:[1,0]
    v_cvt_pk_bf16_f32 v11, v22, v23
    v_pk_mul_f32 v[28:29], v[28:29], s[40:41] op_sel_hi:[1,0]
    v_cvt_pk_bf16_f32 v12, v24, v25
    v_pk_mul_f32 v[30:31], v[30:31], s[40:41] op_sel_hi:[1,0]
    v_cvt_pk_bf16_f32 v13, v26, v27
    ds_write_b128 v218, a[132:135] offset:20064
    v_pk_mul_f32 v[32:33], v[32:33], s[40:41] op_sel_hi:[1,0]
    v_cvt_pk_bf16_f32 v14, v28, v29
    v_pk_mul_f32 v[34:35], v[34:35], s[40:41] op_sel_hi:[1,0]
    v_cvt_pk_bf16_f32 v15, v30, v31
    v_pk_mul_f32 v[36:37], v[36:37], s[40:41] op_sel_hi:[1,0]
    v_cvt_pk_bf16_f32 v16, v32, v33
    v_pk_mul_f32 v[38:39], v[38:39], s[40:41] op_sel_hi:[1,0]
    v_cvt_pk_bf16_f32 v17, v34, v35
    v_pk_mul_f32 v[40:41], v[40:41], s[40:41] op_sel_hi:[1,0]
    v_cvt_pk_bf16_f32 v18, v36, v37
    ds_write_b128 v218, a[136:139] offset:25344
    v_pk_mul_f32 v[42:43], v[42:43], s[40:41] op_sel_hi:[1,0]
    v_cvt_pk_bf16_f32 v19, v38, v39
    v_pk_mul_f32 v[44:45], v[44:45], s[40:41] op_sel_hi:[1,0]
    v_cvt_pk_bf16_f32 v20, v40, v41
    v_pk_mul_f32 v[46:47], v[46:47], s[40:41] op_sel_hi:[1,0]
    v_cvt_pk_bf16_f32 v21, v42, v43
    v_pk_mul_f32 v[48:49], v[48:49], s[40:41] op_sel_hi:[1,0]
    v_cvt_pk_bf16_f32 v22, v44, v45
    v_pk_mul_f32 v[50:51], v[50:51], s[40:41] op_sel_hi:[1,0]
    v_cvt_pk_bf16_f32 v23, v46, v47
    ds_write_b128 v218, a[140:143] offset:26400
    v_pk_mul_f32 v[52:53], v[52:53], s[40:41] op_sel_hi:[1,0]
    v_cvt_pk_bf16_f32 v24, v48, v49
    v_pk_mul_f32 v[54:55], v[54:55], s[40:41] op_sel_hi:[1,0]
    v_cvt_pk_bf16_f32 v25, v50, v51
    v_pk_mul_f32 v[56:57], v[56:57], s[40:41] op_sel_hi:[1,0]
    v_cvt_pk_bf16_f32 v26, v52, v53
    v_pk_mul_f32 v[58:59], v[58:59], s[40:41] op_sel_hi:[1,0]
    v_cvt_pk_bf16_f32 v27, v54, v55
    v_pk_mul_f32 v[60:61], v[60:61], s[40:41] op_sel_hi:[1,0]
    v_cvt_pk_bf16_f32 v28, v56, v57
    ds_write_b128 v218, a[144:147] offset:27456
    v_pk_mul_f32 v[62:63], v[62:63], s[40:41] op_sel_hi:[1,0]
    v_cvt_pk_bf16_f32 v29, v58, v59
    v_pk_mul_f32 v[64:65], v[64:65], s[40:41] op_sel_hi:[1,0]
    v_cvt_pk_bf16_f32 v30, v60, v61
    v_pk_mul_f32 v[66:67], v[66:67], s[40:41] op_sel_hi:[1,0]
    v_cvt_pk_bf16_f32 v31, v62, v63
    v_pk_mul_f32 v[68:69], v[68:69], s[40:41] op_sel_hi:[1,0]
    v_cvt_pk_bf16_f32 v32, v64, v65
    v_pk_mul_f32 v[70:71], v[70:71], s[40:41] op_sel_hi:[1,0]
    v_cvt_pk_bf16_f32 v33, v66, v67
    ds_write_b128 v218, a[148:151] offset:28512
    v_pk_mul_f32 v[72:73], v[72:73], s[40:41] op_sel_hi:[1,0]
    v_cvt_pk_bf16_f32 v34, v68, v69
    v_pk_mul_f32 v[74:75], v[74:75], s[40:41] op_sel_hi:[1,0]
    v_cvt_pk_bf16_f32 v35, v70, v71
    v_pk_mul_f32 v[76:77], v[76:77], s[40:41] op_sel_hi:[1,0]
    v_cvt_pk_bf16_f32 v36, v72, v73
    v_pk_mul_f32 v[78:79], v[78:79], s[40:41] op_sel_hi:[1,0]
    v_cvt_pk_bf16_f32 v37, v74, v75
    v_pk_mul_f32 v[80:81], v[80:81], s[40:41] op_sel_hi:[1,0]
    v_cvt_pk_bf16_f32 v38, v76, v77
    s_waitcnt lgkmcnt(0)
    ds_write_b128 v218, v[160:163] offset:0
    v_pk_mul_f32 v[82:83], v[82:83], s[40:41] op_sel_hi:[1,0]
    v_cvt_pk_bf16_f32 v39, v78, v79
    v_pk_mul_f32 v[84:85], v[84:85], s[40:41] op_sel_hi:[1,0]
    v_cvt_pk_bf16_f32 v40, v80, v81
    v_pk_mul_f32 v[86:87], v[86:87], s[40:41] op_sel_hi:[1,0]
    v_cvt_pk_bf16_f32 v41, v82, v83
    v_pk_mul_f32 v[88:89], v[88:89], s[40:41] op_sel_hi:[1,0]
    v_cvt_pk_bf16_f32 v42, v84, v85
    v_pk_mul_f32 v[90:91], v[90:91], s[40:41] op_sel_hi:[1,0]
    v_cvt_pk_bf16_f32 v43, v86, v87
    ds_write_b128 v218, v[164:167] offset:1056
    v_pk_mul_f32 v[92:93], v[92:93], s[40:41] op_sel_hi:[1,0]
    v_cvt_pk_bf16_f32 v44, v88, v89
    v_pk_mul_f32 v[94:95], v[94:95], s[40:41] op_sel_hi:[1,0]
    v_cvt_pk_bf16_f32 v45, v90, v91
    v_pk_mul_f32 v[96:97], v[96:97], s[40:41] op_sel_hi:[1,0]
    v_cvt_pk_bf16_f32 v46, v92, v93
    v_pk_mul_f32 v[98:99], v[98:99], s[40:41] op_sel_hi:[1,0]
    v_cvt_pk_bf16_f32 v47, v94, v95
    v_pk_mul_f32 v[100:101], v[100:101], s[40:41] op_sel_hi:[1,0]
    v_cvt_pk_bf16_f32 v48, v96, v97
    ds_write_b128 v218, v[168:171] offset:2112
    v_pk_mul_f32 v[102:103], v[102:103], s[40:41] op_sel_hi:[1,0]
    v_cvt_pk_bf16_f32 v49, v98, v99
    v_pk_mul_f32 v[104:105], v[104:105], s[40:41] op_sel_hi:[1,0]
    v_cvt_pk_bf16_f32 v50, v100, v101
    v_pk_mul_f32 v[106:107], v[106:107], s[40:41] op_sel_hi:[1,0]
    v_cvt_pk_bf16_f32 v51, v102, v103
    v_pk_mul_f32 v[108:109], v[108:109], s[40:41] op_sel_hi:[1,0]
    v_cvt_pk_bf16_f32 v52, v104, v105
    v_pk_mul_f32 v[110:111], v[110:111], s[40:41] op_sel_hi:[1,0]
    v_cvt_pk_bf16_f32 v53, v106, v107
    ds_write_b128 v218, v[172:175] offset:3168
    v_pk_mul_f32 v[112:113], v[112:113], s[40:41] op_sel_hi:[1,0]
    v_cvt_pk_bf16_f32 v54, v108, v109
    v_pk_mul_f32 v[114:115], v[114:115], s[40:41] op_sel_hi:[1,0]
    v_cvt_pk_bf16_f32 v55, v110, v111
    v_pk_mul_f32 v[116:117], v[116:117], s[40:41] op_sel_hi:[1,0]
    v_cvt_pk_bf16_f32 v56, v112, v113
    v_pk_mul_f32 v[118:119], v[118:119], s[40:41] op_sel_hi:[1,0]
    v_cvt_pk_bf16_f32 v57, v114, v115
    v_pk_mul_f32 v[120:121], v[120:121], s[40:41] op_sel_hi:[1,0]
    v_cvt_pk_bf16_f32 v58, v116, v117
    ds_write_b128 v218, v[176:179] offset:8448
    v_pk_mul_f32 v[122:123], v[122:123], s[40:41] op_sel_hi:[1,0]
    v_cvt_pk_bf16_f32 v59, v118, v119
    v_pk_mul_f32 v[124:125], v[124:125], s[40:41] op_sel_hi:[1,0]
    v_cvt_pk_bf16_f32 v60, v120, v121
    v_pk_mul_f32 v[126:127], v[126:127], s[40:41] op_sel_hi:[1,0]
    v_cvt_pk_bf16_f32 v61, v122, v123
    v_pk_mul_f32 v[128:129], v[128:129], s[40:41] op_sel_hi:[1,0]
    v_cvt_pk_bf16_f32 v62, v124, v125
    v_pk_mul_f32 v[130:131], v[130:131], s[40:41] op_sel_hi:[1,0]
    v_cvt_pk_bf16_f32 v63, v126, v127
    ds_write_b128 v218, v[180:183] offset:9504
    v_pk_mul_f32 v[132:133], v[132:133], s[40:41] op_sel_hi:[1,0]
    v_cvt_pk_bf16_f32 v64, v128, v129
    v_pk_mul_f32 v[134:135], v[134:135], s[40:41] op_sel_hi:[1,0]
    v_cvt_pk_bf16_f32 v65, v130, v131
    v_pk_mul_f32 v[136:137], v[136:137], s[40:41] op_sel_hi:[1,0]
    v_cvt_pk_bf16_f32 v66, v132, v133
    v_pk_mul_f32 v[138:139], v[138:139], s[40:41] op_sel_hi:[1,0]
    v_cvt_pk_bf16_f32 v67, v134, v135
    v_pk_mul_f32 v[140:141], v[140:141], s[40:41] op_sel_hi:[1,0]
    v_cvt_pk_bf16_f32 v68, v136, v137
    ds_write_b128 v218, v[184:187] offset:10560
    v_pk_mul_f32 v[142:143], v[142:143], s[40:41] op_sel_hi:[1,0]
    v_cvt_pk_bf16_f32 v69, v138, v139
    v_pk_mul_f32 v[144:145], v[144:145], s[40:41] op_sel_hi:[1,0]
    v_cvt_pk_bf16_f32 v70, v140, v141
    v_pk_mul_f32 v[146:147], v[146:147], s[40:41] op_sel_hi:[1,0]
    v_cvt_pk_bf16_f32 v71, v142, v143
    v_pk_mul_f32 v[148:149], v[148:149], s[40:41] op_sel_hi:[1,0]
    v_cvt_pk_bf16_f32 v72, v144, v145
    v_pk_mul_f32 v[150:151], v[150:151], s[40:41] op_sel_hi:[1,0]
    v_cvt_pk_bf16_f32 v73, v146, v147
    ds_write_b128 v218, v[188:191] offset:11616
    v_pk_mul_f32 v[152:153], v[152:153], s[40:41] op_sel_hi:[1,0]
    v_cvt_pk_bf16_f32 v74, v148, v149
    v_pk_mul_f32 v[154:155], v[154:155], s[40:41] op_sel_hi:[1,0]
    v_cvt_pk_bf16_f32 v75, v150, v151
    v_pk_mul_f32 v[156:157], v[156:157], s[40:41] op_sel_hi:[1,0]
    v_cvt_pk_bf16_f32 v76, v152, v153
    v_pk_mul_f32 v[158:159], v[158:159], s[40:41] op_sel_hi:[1,0]
    v_cvt_pk_bf16_f32 v77, v154, v155
    v_cvt_pk_bf16_f32 v78, v156, v157
    v_cvt_pk_bf16_f32 v79, v158, v159
    s_waitcnt lgkmcnt(0)
    v_mov_b64 v[160:161], 0
    v_mov_b64 v[162:163], 0
    v_mov_b64 v[164:165], 0
    v_mov_b64 v[166:167], 0
    v_mov_b64 v[168:169], 0
    v_mov_b64 v[170:171], 0
    v_mov_b64 v[172:173], 0
    v_mov_b64 v[174:175], 0
    v_mov_b64 v[176:177], 0
    v_mov_b64 v[178:179], 0
L_A_m2:
    ds_read_b128 a[248:251], v205 offset:0
    ds_read_b128 a[252:255], v205 offset:64
    ds_read_b128 a[240:243], v205 offset:128
    ds_read_b128 a[244:247], v205 offset:192
    s_waitcnt lgkmcnt(2)
    v_mfma_f32_16x16x32_bf16 v[80:83], a[248:251], v[0:3], v[160:163]
    v_mfma_f32_16x16x32_bf16 v[88:91], a[248:251], v[16:19], v[164:167]
    v_mfma_f32_16x16x32_bf16 v[96:99], a[248:251], v[32:35], v[168:171]
    v_mfma_f32_16x16x32_bf16 v[104:107], a[248:251], v[48:51], v[172:175]
    v_mfma_f32_16x16x32_bf16 v[112:115], a[248:251], v[64:67], v[176:179]
    ds_read_b128 a[248:251], v206 offset:0
    v_mfma_f32_16x16x32_bf16 v[80:83], a[252:255], v[4:7], v[80:83]
    v_mfma_f32_16x16x32_bf16 v[88:91], a[252:255], v[20:23], v[88:91]
    v_mfma_f32_16x16x32_bf16 v[96:99], a[252:255], v[36:39], v[96:99]
    v_mfma_f32_16x16x32_bf16 v[104:107], a[252:255], v[52:55], v[104:107]
    v_mfma_f32_16x16x32_bf16 v[112:115], a[252:255], v[68:71], v[112:115]
    ds_read_b128 a[252:255], v206 offset:64
    s_waitcnt lgkmcnt(2)
    v_mfma_f32_16x16x32_bf16 v[80:83], a[240:243], v[8:11], v[80:83]
    v_mfma_f32_16x16x32_bf16 v[88:91], a[240:243], v[24:27], v[88:91]
    v_mfma_f32_16x16x32_bf16 v[96:99], a[240:243], v[40:43], v[96:99]
    v_mfma_f32_16x16x32_bf16 v[104:107], a[240:243], v[56:59], v[104:107]
    v_mfma_f32_16x16x32_bf16 v[112:115], a[240:243], v[72:75], v[112:115]
    ds_read_b128 a[240:243], v206 offset:128
    v_mfma_f32_16x16x32_bf16 v[80:83], a[244:247], v[12:15], v[80:83]
    v_mfma_f32_16x16x32_bf16 v[88:91], a[244:247], v[28:31], v[88:91]
    v_mfma_f32_16x16x32_bf16 v[96:99], a[244:247], v[44:47], v[96:99]
    v_mfma_f32_16x16x32_bf16 v[104:107], a[244:247], v[60:63], v[104:107]
    v_mfma_f32_16x16x32_bf16 v[112:115], a[244:247], v[76:79], v[112:115]
    ds_read_b128 a[244:247], v206 offset:192
    s_waitcnt lgkmcnt(2)
    v_mfma_f32_16x16x32_bf16 v[84:87], a[248:251], v[0:3], v[160:163]
    v_mfma_f32_16x16x32_bf16 v[92:95], a[248:251], v[16:19], v[164:167]
    v_mfma_f32_16x16x32_bf16 v[100:103], a[248:251], v[32:35], v[168:171]
    v_mfma_f32_16x16x32_bf16 v[108:111], a[248:251], v[48:51], v[172:175]
    v_mfma_f32_16x16x32_bf16 v[116:119], a[248:251], v[64:67], v[176:179]
    v_mfma_f32_16x16x32_bf16 v[84:87], a[252:255], v[4:7], v[84:87]
    v_mfma_f32_16x16x32_bf16 v[92:95], a[252:255], v[20:23], v[92:95]
    v_max3_f32 v234, v80, v81, v82
    v_mfma_f32_16x16x32_bf16 v[100:103], a[252:255], v[36:39], v[100:103]
    v_mfma_f32_16x16x32_bf16 v[108:111], a[252:255], v[52:55], v[108:111]
    v_mfma_f32_16x16x32_bf16 v[116:119], a[252:255], v[68:71], v[116:119]
    s_waitcnt vmcnt(4) lgkmcnt(0)
    s_barrier
L_A_m1:
    ds_read_b128 a[248:251], v205 offset:8448
    ds_read_b128 a[252:255], v205 offset:8512
    v_mfma_f32_16x16x32_bf16 v[84:87], a[240:243], v[8:11], v[84:87]
    v_mfma_f32_16x16x32_bf16 v[92:95], a[240:243], v[24:27], v[92:95]
    v_mfma_f32_16x16x32_bf16 v[100:103], a[240:243], v[40:43], v[100:103]
    v_mfma_f32_16x16x32_bf16 v[108:111], a[240:243], v[56:59], v[108:111]
    v_mfma_f32_16x16x32_bf16 v[116:119], a[240:243], v[72:75], v[116:119]
    v_mfma_f32_16x16x32_bf16 v[84:87], a[244:247], v[12:15], v[84:87]
    v_mfma_f32_16x16x32_bf16 v[92:95], a[244:247], v[28:31], v[92:95]
    v_mfma_f32_16x16x32_bf16 v[100:103], a[244:247], v[44:47], v[100:103]
    v_mfma_f32_16x16x32_bf16 v[108:111], a[244:247], v[60:63], v[108:111]
    v_mfma_f32_16x16x32_bf16 v[116:119], a[244:247], v[76:79], v[116:119]
    s_call_b64 s[50:51], S_first
    v_exp_f32 v80, v80
    s_add_u32 m0, s32, 0
    v_exp_f32 v81, v81
    s_nop 0
    v_cvt_pk_bf16_f32 v80, v80, v81
    buffer_load_dwordx4 v208, s[4:7], 0 offen offset:0 nt lds
    v_exp_f32 v82, v82
    v_exp_f32 v83, v83
    s_add_u32 m0, s32, 32
    v_exp_f32 v84, v84
    v_cvt_pk_bf16_f32 v81, v82, v83
    buffer_load_dwordx4 v208, s[4:7], 0 offen offset:1024 nt lds
    v_exp_f32 v85, v85
    s_nop 0
    v_cvt_pk_bf16_f32 v82, v84, v85
    v_exp_f32 v86, v86
    v_exp_f32 v87, v87
    v_exp_f32 v88, v88
    v_cvt_pk_bf16_f32 v83, v86, v87
    s_add_u32 m0, s32, 64
    v_exp_f32 v89, v89
    s_nop 0
    v_cvt_pk_bf16_f32 v88, v88, v89
    buffer_load_dwordx4 v208, s[4:7], 0 offen offset:2048 nt lds
    v_exp_f32 v90, v90
    s_add_u32 m0, s32, 96
    v_exp_f32 v91, v91
    s_nop 0
    v_cvt_pk_bf16_f32 v89, v90, v91
    buffer_load_dwordx4 v208, s[4:7], 0 offen offset:3072 nt lds
    v_add_u32 v208, s58, v208
    v_exp_f32 v92, v92
    v_exp_f32 v93, v93
    v_exp_f32 v94, v94
    v_cvt_pk_bf16_f32 v90, v92, v93
    v_exp_f32 v95, v95
    ds_read_b128 a[240:243], v205 offset:8576
    v_cvt_pk_bf16_f32 v91, v94, v95
    v_exp_f32 v96, v96
    v_exp_f32 v97, v97
    v_exp_f32 v98, v98
    ds_read_b128 a[244:247], v205 offset:8640
    s_waitcnt lgkmcnt(2)
    v_mfma_f32_16x16x32_bf16 v[120:123], a[248:251], v[0:3], v[160:163]
    v_exp_f32 v99, v99
    v_mfma_f32_16x16x32_bf16 v[128:131], a[248:251], v[16:19], v[164:167]
    v_cvt_pk_bf16_f32 v96, v96, v97
    v_cvt_pk_bf16_f32 v97, v98, v99
    v_mfma_f32_16x16x32_bf16 v[136:139], a[248:251], v[32:35], v[168:171]
    v_exp_f32 v100, v100
    v_mfma_f32_16x16x32_bf16 v[144:147], a[248:251], v[48:51], v[172:175]
    v_exp_f32 v101, v101
    v_mfma_f32_16x16x32_bf16 v[152:155], a[248:251], v[64:67], v[176:179]
    ds_read_b128 a[248:251], v206 offset:8448
    v_mfma_f32_16x16x32_bf16 v[120:123], a[252:255], v[4:7], v[120:123]
    v_cvt_pk_bf16_f32 v98, v100, v101
    v_mfma_f32_16x16x32_bf16 v[128:131], a[252:255], v[20:23], v[128:131]
    v_exp_f32 v102, v102
    v_mfma_f32_16x16x32_bf16 v[136:139], a[252:255], v[36:39], v[136:139]
    v_exp_f32 v103, v103
    v_mfma_f32_16x16x32_bf16 v[144:147], a[252:255], v[52:55], v[144:147]
    v_exp_f32 v104, v104
    v_mfma_f32_16x16x32_bf16 v[152:155], a[252:255], v[68:71], v[152:155]
    ds_read_b128 a[252:255], v206 offset:8512
    s_waitcnt lgkmcnt(2)
    v_mfma_f32_16x16x32_bf16 v[120:123], a[240:243], v[8:11], v[120:123]
    v_cvt_pk_bf16_f32 v99, v102, v103
    v_mfma_f32_16x16x32_bf16 v[128:131], a[240:243], v[24:27], v[128:131]
    v_exp_f32 v105, v105
    v_mfma_f32_16x16x32_bf16 v[136:139], a[240:243], v[40:43], v[136:139]
    v_exp_f32 v106, v106
    v_mfma_f32_16x16x32_bf16 v[144:147], a[240:243], v[56:59], v[144:147]
    v_cvt_pk_bf16_f32 v104, v104, v105
    v_mfma_f32_16x16x32_bf16 v[152:155], a[240:243], v[72:75], v[152:155]
    ds_read_b128 a[240:243], v206 offset:8576
    v_mfma_f32_16x16x32_bf16 v[120:123], a[244:247], v[12:15], v[120:123]
    v_exp_f32 v107, v107
    v_mfma_f32_16x16x32_bf16 v[128:131], a[244:247], v[28:31], v[128:131]
    v_exp_f32 v108, v108
    v_mfma_f32_16x16x32_bf16 v[136:139], a[244:247], v[44:47], v[136:139]
    v_exp_f32 v109, v109
    v_mfma_f32_16x16x32_bf16 v[144:147], a[244:247], v[60:63], v[144:147]
    v_cvt_pk_bf16_f32 v105, v106, v107
    v_cvt_pk_bf16_f32 v106, v108, v109
    v_mfma_f32_16x16x32_bf16 v[152:155], a[244:247], v[76:79], v[152:155]
    ds_read_b128 a[244:247], v206 offset:8640
    s_waitcnt lgkmcnt(2)
    v_mfma_f32_16x16x32_bf16 v[124:127], a[248:251], v[0:3], v[160:163]
    v_exp_f32 v110, v110
    v_mfma_f32_16x16x32_bf16 v[132:135], a[248:251], v[16:19], v[164:167]
    v_exp_f32 v111, v111
    v_mfma_f32_16x16x32_bf16 v[140:143], a[248:251], v[32:35], v[168:171]
    v_cvt_pk_bf16_f32 v107, v110, v111
    v_mfma_f32_16x16x32_bf16 v[148:151], a[248:251], v[48:51], v[172:175]
    v_exp_f32 v112, v112
    v_mfma_f32_16x16x32_bf16 v[156:159], a[248:251], v[64:67], v[176:179]
    v_exp_f32 v113, v113
    v_mfma_f32_16x16x32_bf16 v[124:127], a[252:255], v[4:7], v[124:127]
    v_exp_f32 v114, v114
    v_mfma_f32_16x16x32_bf16 v[132:135], a[252:255], v[20:23], v[132:135]
    v_cvt_pk_bf16_f32 v112, v112, v113
    v_max3_f32 v234, v120, v121, v122
    v_mfma_f32_16x16x32_bf16 v[140:143], a[252:255], v[36:39], v[140:143]
    v_exp_f32 v115, v115
    v_mfma_f32_16x16x32_bf16 v[148:151], a[252:255], v[52:55], v[148:151]
    v_exp_f32 v116, v116
    v_mfma_f32_16x16x32_bf16 v[156:159], a[252:255], v[68:71], v[156:159]
    v_cvt_pk_bf16_f32 v113, v114, v115
    s_waitcnt vmcnt(4) lgkmcnt(0)
    s_barrier
L_A_z0:
    v_mfma_f32_16x16x32_bf16 v[124:127], a[240:243], v[8:11], v[124:127]
    ds_read_b64_tr_b16 a[248:249], v207 offset:16896
    ds_read_b64_tr_b16 a[250:251], v207 offset:17152
    v_mfma_f32_16x16x32_bf16 v[132:135], a[240:243], v[24:27], v[132:135]
    ds_read_b64_tr_b16 a[252:253], v207 offset:16928
    ds_read_b64_tr_b16 a[254:255], v207 offset:17184
    v_mfma_f32_16x16x32_bf16 v[140:143], a[240:243], v[40:43], v[140:143]
    v_max3_f32 v235, v123, v128, v129
    v_max3_f32 v235, v235, v130, v131
    v_mfma_f32_16x16x32_bf16 v[148:151], a[240:243], v[56:59], v[148:151]
    v_exp_f32 v117, v117
    v_mfma_f32_16x16x32_bf16 v[156:159], a[240:243], v[72:75], v[156:159]
    ds_read_b64_tr_b16 a[240:241], v207 offset:16960
    ds_read_b64_tr_b16 a[242:243], v207 offset:17216
    v_mfma_f32_16x16x32_bf16 v[124:127], a[244:247], v[12:15], v[124:127]
    v_exp_f32 v118, v118
    v_mfma_f32_16x16x32_bf16 v[132:135], a[244:247], v[28:31], v[132:135]
    v_exp_f32 v119, v119
    v_mfma_f32_16x16x32_bf16 v[140:143], a[244:247], v[44:47], v[140:143]
    v_cvt_pk_bf16_f32 v114, v116, v117
    v_cvt_pk_bf16_f32 v115, v118, v119
    v_mfma_f32_16x16x32_bf16 v[148:151], a[244:247], v[60:63], v[148:151]
    v_max3_f32 v234, v234, v136, v137
    v_max3_f32 v235, v235, v138, v139
    v_mfma_f32_16x16x32_bf16 v[156:159], a[244:247], v[76:79], v[156:159]
    ds_read_b64_tr_b16 a[244:245], v207 offset:16992
    s_waitcnt lgkmcnt(5)
    v_mfma_f32_16x16x32_bf16 a[0:3], a[248:251], v[80:83], 0
    ds_read_b64_tr_b16 a[246:247], v207 offset:17248
    v_max3_f32 v234, v234, v144, v145
    v_mfma_f32_16x16x32_bf16 a[4:7], a[248:251], v[88:91], 0
    v_max3_f32 v235, v235, v146, v147
    v_max3_f32 v234, v234, v152, v153
    v_mfma_f32_16x16x32_bf16 a[8:11], a[248:251], v[96:99], 0
    v_max3_f32 v235, v235, v154, v155
    v_max3_f32 v234, v234, v124, v125
    v_mfma_f32_16x16x32_bf16 a[12:15], a[248:251], v[104:107], 0
    v_max3_f32 v235, v235, v126, v127
    v_max3_f32 v234, v234, v132, v133
    v_mfma_f32_16x16x32_bf16 a[16:19], a[248:251], v[112:115], 0
    ds_read_b64_tr_b16 a[248:249], v207 offset:17024
    s_waitcnt lgkmcnt(5)
    v_mfma_f32_16x16x32_bf16 a[20:23], a[252:255], v[80:83], 0
    ds_read_b64_tr_b16 a[250:251], v207 offset:17280
    v_max3_f32 v235, v235, v134, v135
    v_mfma_f32_16x16x32_bf16 a[24:27], a[252:255], v[88:91], 0
    v_max3_f32 v234, v234, v140, v141
    v_max3_f32 v235, v235, v142, v143
    v_mfma_f32_16x16x32_bf16 a[28:31], a[252:255], v[96:99], 0
    v_max3_f32 v234, v234, v148, v149
    v_max3_f32 v235, v235, v150, v151
    v_mfma_f32_16x16x32_bf16 a[32:35], a[252:255], v[104:107], 0
    v_max3_f32 v234, v234, v156, v157
    v_max3_f32 v235, v235, v158, v159
    v_mfma_f32_16x16x32_bf16 a[36:39], a[252:255], v[112:115], 0
    ds_read_b64_tr_b16 a[252:253], v207 offset:17056
    ds_read_b64_tr_b16 a[254:255], v207 offset:17312
    v_mfma_f32_16x16x32_bf16 v[180:183], v[200:203], v[80:83], 0
    v_max_f32 v234, v234, v235
    s_waitcnt lgkmcnt(4)
    v_mfma_f32_16x16x32_bf16 a[40:43], a[240:243], v[80:83], 0
    v_cmp_lt_f32 vcc, 0x41000000, v234
    s_cbranch_vccnz L_rrz0
L_rbz0:
    v_mfma_f32_16x16x32_bf16 a[44:47], a[240:243], v[88:91], 0
    v_exp_f32 v120, v120
    v_mfma_f32_16x16x32_bf16 a[48:51], a[240:243], v[96:99], 0
    s_add_u32 m0, s32, 8448
    v_exp_f32 v121, v121
    v_mfma_f32_16x16x32_bf16 a[52:55], a[240:243], v[104:107], 0
    v_cvt_pk_bf16_f32 v120, v120, v121
    buffer_load_dwordx4 v208, s[4:7], 0 offen offset:0 nt lds
    v_mfma_f32_16x16x32_bf16 a[56:59], a[240:243], v[112:115], 0
    ds_read_b64_tr_b16 a[240:241], v207 offset:17088
    ds_read_b64_tr_b16 a[242:243], v207 offset:17344
    v_mfma_f32_16x16x32_bf16 v[184:187], v[200:203], v[88:91], 0
    v_exp_f32 v122, v122
    v_mfma_f32_16x16x32_bf16 a[60:63], a[244:247], v[80:83], 0
    v_exp_f32 v123, v123
    v_mfma_f32_16x16x32_bf16 a[64:67], a[244:247], v[88:91], 0
    s_add_u32 m0, s32, 8480
    v_exp_f32 v124, v124
    v_mfma_f32_16x16x32_bf16 a[68:71], a[244:247], v[96:99], 0
    v_cvt_pk_bf16_f32 v121, v122, v123
    buffer_load_dwordx4 v208, s[4:7], 0 offen offset:1024 nt lds
    v_mfma_f32_16x16x32_bf16 a[72:75], a[244:247], v[104:107], 0
    v_exp_f32 v125, v125
    v_mfma_f32_16x16x32_bf16 a[76:79], a[244:247], v[112:115], 0
    ds_read_b64_tr_b16 a[244:245], v207 offset:17120
    ds_read_b64_tr_b16 a[246:247], v207 offset:17376
    v_mfma_f32_16x16x32_bf16 v[188:191], v[200:203], v[96:99], 0
    v_cvt_pk_bf16_f32 v122, v124, v125
    s_waitcnt lgkmcnt(4)
    v_mfma_f32_16x16x32_bf16 a[80:83], a[248:251], v[80:83], 0
    v_exp_f32 v126, v126
    v_mfma_f32_16x16x32_bf16 a[84:87], a[248:251], v[88:91], 0
    v_mfma_f32_16x16x32_bf16 a[88:91], a[248:251], v[96:99], 0
    v_exp_f32 v127, v127
    v_mfma_f32_16x16x32_bf16 a[92:95], a[248:251], v[104:107], 0
    v_exp_f32 v128, v128
    v_mfma_f32_16x16x32_bf16 a[96:99], a[248:251], v[112:115], 0
    ds_read_b128 a[248:251], v205 offset:16896
    v_cvt_pk_bf16_f32 v123, v126, v127
    v_mfma_f32_16x16x32_bf16 v[192:195], v[200:203], v[104:107], 0
    s_add_u32 m0, s32, 8512
    v_exp_f32 v129, v129
    v_mfma_f32_16x16x32_bf16 a[100:103], a[252:255], v[80:83], 0
    v_cvt_pk_bf16_f32 v128, v128, v129
    buffer_load_dwordx4 v208, s[4:7], 0 offen offset:2048 nt lds
    v_mfma_f32_16x16x32_bf16 a[104:107], a[252:255], v[88:91], 0
    v_exp_f32 v130, v130
    v_mfma_f32_16x16x32_bf16 a[108:111], a[252:255], v[96:99], 0
    s_add_u32 m0, s32, 8544
    v_exp_f32 v131, v131
    v_mfma_f32_16x16x32_bf16 a[112:115], a[252:255], v[104:107], 0
    v_cvt_pk_bf16_f32 v129, v130, v131
    buffer_load_dwordx4 v208, s[4:7], 0 offen offset:3072 nt lds
    v_add_u32 v208, s58, v208
    v_mfma_f32_16x16x32_bf16 a[116:119], a[252:255], v[112:115], 0
    v_exp_f32 v132, v132
    v_mfma_f32_16x16x32_bf16 v[196:199], v[200:203], v[112:115], 0
    ds_read_b128 a[252:255], v205 offset:16960
    s_waitcnt lgkmcnt(2)
    v_mfma_f32_16x16x32_bf16 a[120:123], a[240:243], v[80:83], 0
    v_exp_f32 v133, v133
    v_mfma_f32_16x16x32_bf16 a[124:127], a[240:243], v[88:91], 0
    v_exp_f32 v134, v134
    v_mfma_f32_16x16x32_bf16 a[128:131], a[240:243], v[96:99], 0
    v_cvt_pk_bf16_f32 v130, v132, v133
    v_mfma_f32_16x16x32_bf16 a[132:135], a[240:243], v[104:107], 0
    v_exp_f32 v135, v135
    v_mfma_f32_16x16x32_bf16 a[136:139], a[240:243], v[112:115], 0
    ds_read_b128 a[240:243], v205 offset:17024
    v_cvt_pk_bf16_f32 v131, v134, v135
    buffer_load_dword v252, v221, s[8:11], 0 offen
    v_mfma_f32_16x16x32_bf16 a[140:143], a[244:247], v[80:83], 0
    v_exp_f32 v136, v136
    v_mfma_f32_16x16x32_bf16 a[144:147], a[244:247], v[88:91], 0
    v_mfma_f32_16x16x32_bf16 a[148:151], a[244:247], v[96:99], 0
    v_exp_f32 v137, v137
    v_mfma_f32_16x16x32_bf16 a[152:155], a[244:247], v[104:107], 0
    v_exp_f32 v138, v138
    v_mfma_f32_16x16x32_bf16 a[156:159], a[244:247], v[112:115], 0
    ds_read_b128 a[244:247], v205 offset:17088
    s_waitcnt lgkmcnt(2)
    v_mfma_f32_16x16x32_bf16 v[80:83], a[248:251], v[0:3], v[160:163]
    v_exp_f32 v139, v139
    v_mfma_f32_16x16x32_bf16 v[88:91], a[248:251], v[16:19], v[164:167]
    v_cvt_pk_bf16_f32 v136, v136, v137
    v_cvt_pk_bf16_f32 v137, v138, v139
    v_mfma_f32_16x16x32_bf16 v[96:99], a[248:251], v[32:35], v[168:171]
    v_exp_f32 v140, v140
    v_mfma_f32_16x16x32_bf16 v[104:107], a[248:251], v[48:51], v[172:175]
    v_exp_f32 v141, v141
    v_mfma_f32_16x16x32_bf16 v[112:115], a[248:251], v[64:67], v[176:179]
    ds_read_b128 a[248:251], v206 offset:16896
    s_cbranch_vccnz L_p2z0
L_pbz0:
    buffer_load_dword v252, v221, s[8:11], 0 offen
    v_mfma_f32_16x16x32_bf16 v[80:83], a[252:255], v[4:7], v[80:83]
    v_cvt_pk_bf16_f32 v138, v140, v141
    v_mfma_f32_16x16x32_bf16 v[88:91], a[252:255], v[20:23], v[88:91]
    v_exp_f32 v142, v142
    v_mfma_f32_16x16x32_bf16 v[96:99], a[252:255], v[36:39], v[96:99]
    v_exp_f32 v143, v143
    v_mfma_f32_16x16x32_bf16 v[104:107], a[252:255], v[52:55], v[104:107]
    v_exp_f32 v144, v144
    v_mfma_f32_16x16x32_bf16 v[112:115], a[252:255], v[68:71], v[112:115]
    ds_read_b128 a[252:255], v206 offset:16960
    s_waitcnt lgkmcnt(2)
    v_mfma_f32_16x16x32_bf16 v[80:83], a[240:243], v[8:11], v[80:83]
    v_cvt_pk_bf16_f32 v139, v142, v143
    v_mfma_f32_16x16x32_bf16 v[88:91], a[240:243], v[24:27], v[88:91]
    v_exp_f32 v145, v145
    v_mfma_f32_16x16x32_bf16 v[96:99], a[240:243], v[40:43], v[96:99]
    v_exp_f32 v146, v146
    v_mfma_f32_16x16x32_bf16 v[104:107], a[240:243], v[56:59], v[104:107]
    v_cvt_pk_bf16_f32 v144, v144, v145
    v_mfma_f32_16x16x32_bf16 v[112:115], a[240:243], v[72:75], v[112:115]
    ds_read_b128 a[240:243], v206 offset:17024
    buffer_load_dword v252, v221, s[8:11], 0 offen
    v_mfma_f32_16x16x32_bf16 v[80:83], a[244:247], v[12:15], v[80:83]
    v_exp_f32 v147, v147
    v_mfma_f32_16x16x32_bf16 v[88:91], a[244:247], v[28:31], v[88:91]
    v_exp_f32 v148, v148
    v_mfma_f32_16x16x32_bf16 v[96:99], a[244:247], v[44:47], v[96:99]
    v_exp_f32 v149, v149
    v_mfma_f32_16x16x32_bf16 v[104:107], a[244:247], v[60:63], v[104:107]
    v_cvt_pk_bf16_f32 v145, v146, v147
    v_cvt_pk_bf16_f32 v146, v148, v149
    v_mfma_f32_16x16x32_bf16 v[112:115], a[244:247], v[76:79], v[112:115]
    ds_read_b128 a[244:247], v206 offset:17088
    s_waitcnt lgkmcnt(2)
    v_mfma_f32_16x16x32_bf16 v[84:87], a[248:251], v[0:3], v[160:163]
    v_exp_f32 v150, v150
    v_mfma_f32_16x16x32_bf16 v[92:95], a[248:251], v[16:19], v[164:167]
    v_exp_f32 v151, v151
    v_mfma_f32_16x16x32_bf16 v[100:103], a[248:251], v[32:35], v[168:171]
    v_cvt_pk_bf16_f32 v147, v150, v151
    v_mfma_f32_16x16x32_bf16 v[108:111], a[248:251], v[48:51], v[172:175]
    v_exp_f32 v152, v152
    v_mfma_f32_16x16x32_bf16 v[116:119], a[248:251], v[64:67], v[176:179]
    v_exp_f32 v153, v153
    buffer_load_dword v252, v221, s[8:11], 0 offen
    v_mfma_f32_16x16x32_bf16 v[84:87], a[252:255], v[4:7], v[84:87]
    v_exp_f32 v154, v154
    v_mfma_f32_16x16x32_bf16 v[92:95], a[252:255], v[20:23], v[92:95]
    v_cvt_pk_bf16_f32 v152, v152, v153
    v_max3_f32 v234, v80, v81, v82
    v_mfma_f32_16x16x32_bf16 v[100:103], a[252:255], v[36:39], v[100:103]
    v_exp_f32 v155, v155
    v_mfma_f32_16x16x32_bf16 v[108:111], a[252:255], v[52:55], v[108:111]
    v_exp_f32 v156, v156
    v_mfma_f32_16x16x32_bf16 v[116:119], a[252:255], v[68:71], v[116:119]
    v_cvt_pk_bf16_f32 v153, v154, v155
    s_waitcnt vmcnt(63) lgkmcnt(0)
    s_mov_b32 s31, 0
    s_barrier
L_A_l1:
    v_mfma_f32_16x16x32_bf16 v[84:87], a[240:243], v[8:11], v[84:87]
    ds_read_b64_tr_b16 a[248:249], v207 offset:25344
    ds_read_b64_tr_b16 a[250:251], v207 offset:25600
    v_mfma_f32_16x16x32_bf16 v[92:95], a[240:243], v[24:27], v[92:95]
    ds_read_b64_tr_b16 a[252:253], v207 offset:25376
    ds_read_b64_tr_b16 a[254:255], v207 offset:25632
    v_mfma_f32_16x16x32_bf16 v[100:103], a[240:243], v[40:43], v[100:103]
    v_max3_f32 v235, v83, v88, v89
    v_max3_f32 v235, v235, v90, v91
    v_mfma_f32_16x16x32_bf16 v[108:111], a[240:243], v[56:59], v[108:111]
    v_exp_f32 v157, v157
    v_mfma_f32_16x16x32_bf16 v[116:119], a[240:243], v[72:75], v[116:119]
    ds_read_b64_tr_b16 a[240:241], v207 offset:25408
    ds_read_b64_tr_b16 a[242:243], v207 offset:25664
    v_mfma_f32_16x16x32_bf16 v[84:87], a[244:247], v[12:15], v[84:87]
    v_exp_f32 v158, v158
    v_mfma_f32_16x16x32_bf16 v[92:95], a[244:247], v[28:31], v[92:95]
    v_exp_f32 v159, v159
    v_mfma_f32_16x16x32_bf16 v[100:103], a[244:247], v[44:47], v[100:103]
    v_cvt_pk_bf16_f32 v154, v156, v157
    v_cvt_pk_bf16_f32 v155, v158, v159
    v_mfma_f32_16x16x32_bf16 v[108:111], a[244:247], v[60:63], v[108:111]
    v_max3_f32 v234, v234, v96, v97
    v_max3_f32 v235, v235, v98, v99
    v_mfma_f32_16x16x32_bf16 v[116:119], a[244:247], v[76:79], v[116:119]
    ds_read_b64_tr_b16 a[244:245], v207 offset:25440
    s_waitcnt lgkmcnt(5)
    v_mfma_f32_16x16x32_bf16 a[0:3], a[248:251], v[120:123], a[0:3]
    ds_read_b64_tr_b16 a[246:247], v207 offset:25696
    v_max3_f32 v234, v234, v104, v105
    v_mfma_f32_16x16x32_bf16 a[4:7], a[248:251], v[128:131], a[4:7]
    v_max3_f32 v235, v235, v106, v107
    v_max3_f32 v234, v234, v112, v113
    v_mfma_f32_16x16x32_bf16 a[8:11], a[248:251], v[136:139], a[8:11]
    v_max3_f32 v235, v235, v114, v115
    v_max3_f32 v234, v234, v84, v85
    v_mfma_f32_16x16x32_bf16 a[12:15], a[248:251], v[144:147], a[12:15]
    v_max3_f32 v235, v235, v86, v87
    v_max3_f32 v234, v234, v92, v93
    v_mfma_f32_16x16x32_bf16 a[16:19], a[248:251], v[152:155], a[16:19]
    ds_read_b64_tr_b16 a[248:249], v207 offset:25472
    s_waitcnt lgkmcnt(5)
    v_mfma_f32_16x16x32_bf16 a[20:23], a[252:255], v[120:123], a[20:23]
    ds_read_b64_tr_b16 a[250:251], v207 offset:25728
    v_max3_f32 v235, v235, v94, v95
    v_mfma_f32_16x16x32_bf16 a[24:27], a[252:255], v[128:131], a[24:27]
    v_max3_f32 v234, v234, v100, v101
    v_max3_f32 v235, v235, v102, v103
    v_mfma_f32_16x16x32_bf16 a[28:31], a[252:255], v[136:139], a[28:31]
    v_max3_f32 v234, v234, v108, v109
    v_max3_f32 v235, v235, v110, v111
    v_mfma_f32_16x16x32_bf16 a[32:35], a[252:255], v[144:147], a[32:35]
    v_max3_f32 v234, v234, v116, v117
    v_max3_f32 v235, v235, v118, v119
    v_mfma_f32_16x16x32_bf16 a[36:39], a[252:255], v[152:155], a[36:39]
    ds_read_b64_tr_b16 a[252:253], v207 offset:25504
    ds_read_b64_tr_b16 a[254:255], v207 offset:25760
    v_mfma_f32_16x16x32_bf16 v[180:183], v[200:203], v[120:123], v[180:183]
    v_max_f32 v234, v234, v235
    s_waitcnt lgkmcnt(4)
    v_mfma_f32_16x16x32_bf16 a[40:43], a[240:243], v[120:123], a[40:43]
    v_cmp_lt_f32 vcc, 0x41000000, v234
    s_cbranch_vccnz L_rrl1
L_rbl1:
    v_mfma_f32_16x16x32_bf16 a[44:47], a[240:243], v[128:131], a[44:47]
    v_exp_f32 v80, v80
    v_mfma_f32_16x16x32_bf16 a[48:51], a[240:243], v[136:139], a[48:51]
    s_add_u32 m0, s32, 16896
    v_exp_f32 v81, v81
    v_mfma_f32_16x16x32_bf16 a[52:55], a[240:243], v[144:147], a[52:55]
    v_cvt_pk_bf16_f32 v80, v80, v81
    buffer_load_dwordx4 v208, s[4:7], 0 offen offset:0 nt lds
    v_mfma_f32_16x16x32_bf16 a[56:59], a[240:243], v[152:155], a[56:59]
    ds_read_b64_tr_b16 a[240:241], v207 offset:25536
    ds_read_b64_tr_b16 a[242:243], v207 offset:25792
    v_mfma_f32_16x16x32_bf16 v[184:187], v[200:203], v[128:131], v[184:187]
    v_exp_f32 v82, v82
    v_mfma_f32_16x16x32_bf16 a[60:63], a[244:247], v[120:123], a[60:63]
    v_exp_f32 v83, v83
    v_mfma_f32_16x16x32_bf16 a[64:67], a[244:247], v[128:131], a[64:67]
    s_add_u32 m0, s32, 16928
    v_exp_f32 v84, v84
    v_mfma_f32_16x16x32_bf16 a[68:71], a[244:247], v[136:139], a[68:71]
    v_cvt_pk_bf16_f32 v81, v82, v83
    buffer_load_dwordx4 v208, s[4:7], 0 offen offset:1024 nt lds
    v_mfma_f32_16x16x32_bf16 a[72:75], a[244:247], v[144:147], a[72:75]
    v_exp_f32 v85, v85
    v_mfma_f32_16x16x32_bf16 a[76:79], a[244:247], v[152:155], a[76:79]
    ds_read_b64_tr_b16 a[244:245], v207 offset:25568
    ds_read_b64_tr_b16 a[246:247], v207 offset:25824
    v_mfma_f32_16x16x32_bf16 v[188:191], v[200:203], v[136:139], v[188:191]
    v_cvt_pk_bf16_f32 v82, v84, v85
    s_waitcnt lgkmcnt(4)
    v_mfma_f32_16x16x32_bf16 a[80:83], a[248:251], v[120:123], a[80:83]
    v_exp_f32 v86, v86
    v_mfma_f32_16x16x32_bf16 a[84:87], a[248:251], v[128:131], a[84:87]
    v_mfma_f32_16x16x32_bf16 a[88:91], a[248:251], v[136:139], a[88:91]
    v_exp_f32 v87, v87
    v_mfma_f32_16x16x32_bf16 a[92:95], a[248:251], v[144:147], a[92:95]
    v_exp_f32 v88, v88
    v_mfma_f32_16x16x32_bf16 a[96:99], a[248:251], v[152:155], a[96:99]
    ds_read_b128 a[248:251], v205 offset:25344
    v_cvt_pk_bf16_f32 v83, v86, v87
    v_mfma_f32_16x16x32_bf16 v[192:195], v[200:203], v[144:147], v[192:195]
    s_add_u32 m0, s32, 16960
    v_exp_f32 v89, v89
    v_mfma_f32_16x16x32_bf16 a[100:103], a[252:255], v[120:123], a[100:103]
    v_cvt_pk_bf16_f32 v88, v88, v89
    buffer_load_dwordx4 v208, s[4:7], 0 offen offset:2048 nt lds
    v_mfma_f32_16x16x32_bf16 a[104:107], a[252:255], v[128:131], a[104:107]
    v_exp_f32 v90, v90
    v_mfma_f32_16x16x32_bf16 a[108:111], a[252:255], v[136:139], a[108:111]
    s_add_u32 m0, s32, 16992
    v_exp_f32 v91, v91
    v_mfma_f32_16x16x32_bf16 a[112:115], a[252:255], v[144:147], a[112:115]
    v_cvt_pk_bf16_f32 v89, v90, v91
    buffer_load_dwordx4 v208, s[4:7], 0 offen offset:3072 nt lds
    v_add_u32 v208, s58, v208
    v_mfma_f32_16x16x32_bf16 a[116:119], a[252:255], v[152:155], a[116:119]
    v_exp_f32 v92, v92
    v_mfma_f32_16x16x32_bf16 v[196:199], v[200:203], v[152:155], v[196:199]
    ds_read_b128 a[252:255], v205 offset:25408
    s_waitcnt lgkmcnt(2)
    v_mfma_f32_16x16x32_bf16 a[120:123], a[240:243], v[120:123], a[120:123]
    v_exp_f32 v93, v93
    v_mfma_f32_16x16x32_bf16 a[124:127], a[240:243], v[128:131], a[124:127]
    v_exp_f32 v94, v94
    v_mfma_f32_16x16x32_bf16 a[128:131], a[240:243], v[136:139], a[128:131]
    v_cvt_pk_bf16_f32 v90, v92, v93
    v_mfma_f32_16x16x32_bf16 a[132:135], a[240:243], v[144:147], a[132:135]
    v_exp_f32 v95, v95
    v_mfma_f32_16x16x32_bf16 a[136:139], a[240:243], v[152:155], a[136:139]
    ds_read_b128 a[240:243], v205 offset:25472
    v_cvt_pk_bf16_f32 v91, v94, v95
    v_mfma_f32_16x16x32_bf16 a[140:143], a[244:247], v[120:123], a[140:143]
    s_add_u32 m0, s33, 16896
    v_exp_f32 v96, v96
    v_mfma_f32_16x16x32_bf16 a[144:147], a[244:247], v[128:131], a[144:147]
    buffer_load_dwordx4 v209, s[8:11], 0 offen offset:0 nt lds
    v_mfma_f32_16x16x32_bf16 a[148:151], a[244:247], v[136:139], a[148:151]
    v_exp_f32 v97, v97
    v_mfma_f32_16x16x32_bf16 a[152:155], a[244:247], v[144:147], a[152:155]
    v_exp_f32 v98, v98
    v_mfma_f32_16x16x32_bf16 a[156:159], a[244:247], v[152:155], a[156:159]
    ds_read_b128 a[244:247], v205 offset:25536
    s_waitcnt lgkmcnt(2)
    v_mfma_f32_16x16x32_bf16 v[120:123], a[248:251], v[0:3], v[160:163]
    v_exp_f32 v99, v99
    v_mfma_f32_16x16x32_bf16 v[128:131], a[248:251], v[16:19], v[164:167]
    v_cvt_pk_bf16_f32 v96, v96, v97
    v_cvt_pk_bf16_f32 v97, v98, v99
    v_mfma_f32_16x16x32_bf16 v[136:139], a[248:251], v[32:35], v[168:171]
    v_exp_f32 v100, v100
    v_mfma_f32_16x16x32_bf16 v[144:147], a[248:251], v[48:51], v[172:175]
    v_exp_f32 v101, v101
    v_mfma_f32_16x16x32_bf16 v[152:155], a[248:251], v[64:67], v[176:179]
    s_add_u32 m0, s33, 16928
    ds_read_b128 a[248:251], v206 offset:25344
    s_cbranch_vccnz L_p2l1
L_pbl1:
    v_mfma_f32_16x16x32_bf16 v[120:123], a[252:255], v[4:7], v[120:123]
    v_cvt_pk_bf16_f32 v98, v100, v101
    buffer_load_dwordx4 v209, s[8:11], 0 offen offset:1024 nt lds
    v_mfma_f32_16x16x32_bf16 v[128:131], a[252:255], v[20:23], v[128:131]
    v_exp_f32 v102, v102
    v_mfma_f32_16x16x32_bf16 v[136:139], a[252:255], v[36:39], v[136:139]
    v_exp_f32 v103, v103
    v_mfma_f32_16x16x32_bf16 v[144:147], a[252:255], v[52:55], v[144:147]
    v_exp_f32 v104, v104
    v_mfma_f32_16x16x32_bf16 v[152:155], a[252:255], v[68:71], v[152:155]
    ds_read_b128 a[252:255], v206 offset:25408
    s_waitcnt lgkmcnt(2)
    v_mfma_f32_16x16x32_bf16 v[120:123], a[240:243], v[8:11], v[120:123]
    v_cvt_pk_bf16_f32 v99, v102, v103
    v_mfma_f32_16x16x32_bf16 v[128:131], a[240:243], v[24:27], v[128:131]
    v_exp_f32 v105, v105
    v_mfma_f32_16x16x32_bf16 v[136:139], a[240:243], v[40:43], v[136:139]
    s_add_u32 m0, s33, 16960
    v_exp_f32 v106, v106
    v_mfma_f32_16x16x32_bf16 v[144:147], a[240:243], v[56:59], v[144:147]
    v_cvt_pk_bf16_f32 v104, v104, v105
    buffer_load_dwordx4 v209, s[8:11], 0 offen offset:2048 nt lds
    v_mfma_f32_16x16x32_bf16 v[152:155], a[240:243], v[72:75], v[152:155]
    s_add_u32 m0, s33, 16992
    ds_read_b128 a[240:243], v206 offset:25472
    buffer_load_dwordx4 v209, s[8:11], 0 offen offset:3072 nt lds
    v_add_u32 v209, s58, v209
    v_mfma_f32_16x16x32_bf16 v[120:123], a[244:247], v[12:15], v[120:123]
    v_exp_f32 v107, v107
    v_mfma_f32_16x16x32_bf16 v[128:131], a[244:247], v[28:31], v[128:131]
    v_exp_f32 v108, v108
    v_mfma_f32_16x16x32_bf16 v[136:139], a[244:247], v[44:47], v[136:139]
    v_exp_f32 v109, v109
    v_mfma_f32_16x16x32_bf16 v[144:147], a[244:247], v[60:63], v[144:147]
    v_cvt_pk_bf16_f32 v105, v106, v107
    v_cvt_pk_bf16_f32 v106, v108, v109
    v_mfma_f32_16x16x32_bf16 v[152:155], a[244:247], v[76:79], v[152:155]
    ds_read_b128 a[244:247], v206 offset:25536
    s_waitcnt lgkmcnt(2)
    v_mfma_f32_16x16x32_bf16 v[124:127], a[248:251], v[0:3], v[160:163]
    v_exp_f32 v110, v110
    v_mfma_f32_16x16x32_bf16 v[132:135], a[248:251], v[16:19], v[164:167]
    v_exp_f32 v111, v111
    v_mfma_f32_16x16x32_bf16 v[140:143], a[248:251], v[32:35], v[168:171]
    v_cvt_pk_bf16_f32 v107, v110, v111
    v_mfma_f32_16x16x32_bf16 v[148:151], a[248:251], v[48:51], v[172:175]
    v_exp_f32 v112, v112
    v_mfma_f32_16x16x32_bf16 v[156:159], a[248:251], v[64:67], v[176:179]
    v_exp_f32 v113, v113
    v_mfma_f32_16x16x32_bf16 v[124:127], a[252:255], v[4:7], v[124:127]
    v_exp_f32 v114, v114
    v_mfma_f32_16x16x32_bf16 v[132:135], a[252:255], v[20:23], v[132:135]
    v_cvt_pk_bf16_f32 v112, v112, v113
    v_max3_f32 v234, v120, v121, v122
    v_mfma_f32_16x16x32_bf16 v[140:143], a[252:255], v[36:39], v[140:143]
    v_exp_f32 v115, v115
    v_mfma_f32_16x16x32_bf16 v[148:151], a[252:255], v[52:55], v[148:151]
    v_exp_f32 v116, v116
    v_mfma_f32_16x16x32_bf16 v[156:159], a[252:255], v[68:71], v[156:159]
    v_cvt_pk_bf16_f32 v113, v114, v115
    s_cmp_eq_u32 s34, 1
    s_cbranch_scc1 L_ewl1
    s_waitcnt vmcnt(4)
L_ewl1:
    s_waitcnt vmcnt(6) lgkmcnt(0)
    s_barrier
L_A_l2:
    v_mfma_f32_16x16x32_bf16 v[124:127], a[240:243], v[8:11], v[124:127]
    ds_read_b64_tr_b16 a[248:249], v207 offset:0
    ds_read_b64_tr_b16 a[250:251], v207 offset:256
    v_mfma_f32_16x16x32_bf16 v[132:135], a[240:243], v[24:27], v[132:135]
    ds_read_b64_tr_b16 a[252:253], v207 offset:32
    ds_read_b64_tr_b16 a[254:255], v207 offset:288
    v_mfma_f32_16x16x32_bf16 v[140:143], a[240:243], v[40:43], v[140:143]
    v_max3_f32 v235, v123, v128, v129
    v_max3_f32 v235, v235, v130, v131
    v_mfma_f32_16x16x32_bf16 v[148:151], a[240:243], v[56:59], v[148:151]
    v_exp_f32 v117, v117
    v_mfma_f32_16x16x32_bf16 v[156:159], a[240:243], v[72:75], v[156:159]
    ds_read_b64_tr_b16 a[240:241], v207 offset:64
    ds_read_b64_tr_b16 a[242:243], v207 offset:320
    v_mfma_f32_16x16x32_bf16 v[124:127], a[244:247], v[12:15], v[124:127]
    v_exp_f32 v118, v118
    v_mfma_f32_16x16x32_bf16 v[132:135], a[244:247], v[28:31], v[132:135]
    v_exp_f32 v119, v119
    v_mfma_f32_16x16x32_bf16 v[140:143], a[244:247], v[44:47], v[140:143]
    v_cvt_pk_bf16_f32 v114, v116, v117
    v_cvt_pk_bf16_f32 v115, v118, v119
    v_mfma_f32_16x16x32_bf16 v[148:151], a[244:247], v[60:63], v[148:151]
    v_max3_f32 v234, v234, v136, v137
    v_max3_f32 v235, v235, v138, v139
    v_mfma_f32_16x16x32_bf16 v[156:159], a[244:247], v[76:79], v[156:159]
    ds_read_b64_tr_b16 a[244:245], v207 offset:96
    s_waitcnt lgkmcnt(5)
    v_mfma_f32_16x16x32_bf16 a[0:3], a[248:251], v[80:83], a[0:3]
    ds_read_b64_tr_b16 a[246:247], v207 offset:352
    v_max3_f32 v234, v234, v144, v145
    v_mfma_f32_16x16x32_bf16 a[4:7], a[248:251], v[88:91], a[4:7]
    v_max3_f32 v235, v235, v146, v147
    v_max3_f32 v234, v234, v152, v153
    v_mfma_f32_16x16x32_bf16 a[8:11], a[248:251], v[96:99], a[8:11]
    v_max3_f32 v235, v235, v154, v155
    v_max3_f32 v234, v234, v124, v125
    v_mfma_f32_16x16x32_bf16 a[12:15], a[248:251], v[104:107], a[12:15]
    v_max3_f32 v235, v235, v126, v127
    v_max3_f32 v234, v234, v132, v133
    v_mfma_f32_16x16x32_bf16 a[16:19], a[248:251], v[112:115], a[16:19]
    ds_read_b64_tr_b16 a[248:249], v207 offset:128
    s_waitcnt lgkmcnt(5)
    v_mfma_f32_16x16x32_bf16 a[20:23], a[252:255], v[80:83], a[20:23]
    ds_read_b64_tr_b16 a[250:251], v207 offset:384
    v_max3_f32 v235, v235, v134, v135
    v_mfma_f32_16x16x32_bf16 a[24:27], a[252:255], v[88:91], a[24:27]
    v_max3_f32 v234, v234, v140, v141
    v_max3_f32 v235, v235, v142, v143
    v_mfma_f32_16x16x32_bf16 a[28:31], a[252:255], v[96:99], a[28:31]
    v_max3_f32 v234, v234, v148, v149
    v_max3_f32 v235, v235, v150, v151
    v_mfma_f32_16x16x32_bf16 a[32:35], a[252:255], v[104:107], a[32:35]
    v_max3_f32 v234, v234, v156, v157
    v_max3_f32 v235, v235, v158, v159
    v_mfma_f32_16x16x32_bf16 a[36:39], a[252:255], v[112:115], a[36:39]
    ds_read_b64_tr_b16 a[252:253], v207 offset:160
    ds_read_b64_tr_b16 a[254:255], v207 offset:416
    v_mfma_f32_16x16x32_bf16 v[180:183], v[200:203], v[80:83], v[180:183]
    v_max_f32 v234, v234, v235
    s_waitcnt lgkmcnt(4)
    v_mfma_f32_16x16x32_bf16 a[40:43], a[240:243], v[80:83], a[40:43]
    v_cmp_lt_f32 vcc, 0x41000000, v234
    s_cbranch_vccnz L_rrl2
L_rbl2:
    v_mfma_f32_16x16x32_bf16 a[44:47], a[240:243], v[88:91], a[44:47]
    v_exp_f32 v120, v120
    v_mfma_f32_16x16x32_bf16 a[48:51], a[240:243], v[96:99], a[48:51]
    s_add_u32 m0, s32, 25344
    v_exp_f32 v121, v121
    v_mfma_f32_16x16x32_bf16 a[52:55], a[240:243], v[104:107], a[52:55]
    v_cvt_pk_bf16_f32 v120, v120, v121
    buffer_load_dwordx4 v208, s[4:7], 0 offen offset:0 nt lds
    v_mfma_f32_16x16x32_bf16 a[56:59], a[240:243], v[112:115], a[56:59]
    ds_read_b64_tr_b16 a[240:241], v207 offset:192
    ds_read_b64_tr_b16 a[242:243], v207 offset:448
    v_mfma_f32_16x16x32_bf16 v[184:187], v[200:203], v[88:91], v[184:187]
    v_exp_f32 v122, v122
    v_mfma_f32_16x16x32_bf16 a[60:63], a[244:247], v[80:83], a[60:63]
    v_exp_f32 v123, v123
    v_mfma_f32_16x16x32_bf16 a[64:67], a[244:247], v[88:91], a[64:67]
    s_add_u32 m0, s32, 25376
    v_exp_f32 v124, v124
    v_mfma_f32_16x16x32_bf16 a[68:71], a[244:247], v[96:99], a[68:71]
    v_cvt_pk_bf16_f32 v121, v122, v123
    buffer_load_dwordx4 v208, s[4:7], 0 offen offset:1024 nt lds
    v_mfma_f32_16x16x32_bf16 a[72:75], a[244:247], v[104:107], a[72:75]
    v_exp_f32 v125, v125
    v_mfma_f32_16x16x32_bf16 a[76:79], a[244:247], v[112:115], a[76:79]
    ds_read_b64_tr_b16 a[244:245], v207 offset:224
    ds_read_b64_tr_b16 a[246:247], v207 offset:480
    v_mfma_f32_16x16x32_bf16 v[188:191], v[200:203], v[96:99], v[188:191]
    v_cvt_pk_bf16_f32 v122, v124, v125
    s_waitcnt lgkmcnt(4)
    v_mfma_f32_16x16x32_bf16 a[80:83], a[248:251], v[80:83], a[80:83]
    v_exp_f32 v126, v126
    v_mfma_f32_16x16x32_bf16 a[84:87], a[248:251], v[88:91], a[84:87]
    v_mfma_f32_16x16x32_bf16 a[88:91], a[248:251], v[96:99], a[88:91]
    v_exp_f32 v127, v127
    v_mfma_f32_16x16x32_bf16 a[92:95], a[248:251], v[104:107], a[92:95]
    v_exp_f32 v128, v128
    v_mfma_f32_16x16x32_bf16 a[96:99], a[248:251], v[112:115], a[96:99]
    ds_read_b128 a[248:251], v205 offset:0
    v_cvt_pk_bf16_f32 v123, v126, v127
    v_mfma_f32_16x16x32_bf16 v[192:195], v[200:203], v[104:107], v[192:195]
    s_add_u32 m0, s32, 25408
    v_exp_f32 v129, v129
    v_mfma_f32_16x16x32_bf16 a[100:103], a[252:255], v[80:83], a[100:103]
    v_cvt_pk_bf16_f32 v128, v128, v129
    buffer_load_dwordx4 v208, s[4:7], 0 offen offset:2048 nt lds
    v_mfma_f32_16x16x32_bf16 a[104:107], a[252:255], v[88:91], a[104:107]
    v_exp_f32 v130, v130
    v_mfma_f32_16x16x32_bf16 a[108:111], a[252:255], v[96:99], a[108:111]
    s_add_u32 m0, s32, 25440
    v_exp_f32 v131, v131
    v_mfma_f32_16x16x32_bf16 a[112:115], a[252:255], v[104:107], a[112:115]
    v_cvt_pk_bf16_f32 v129, v130, v131
    buffer_load_dwordx4 v208, s[4:7], 0 offen offset:3072 nt lds
    v_add_u32 v208, s58, v208
    v_mfma_f32_16x16x32_bf16 a[116:119], a[252:255], v[112:115], a[116:119]
    v_exp_f32 v132, v132
    v_mfma_f32_16x16x32_bf16 v[196:199], v[200:203], v[112:115], v[196:199]
    ds_read_b128 a[252:255], v205 offset:64
    s_waitcnt lgkmcnt(2)
    v_mfma_f32_16x16x32_bf16 a[120:123], a[240:243], v[80:83], a[120:123]
    v_exp_f32 v133, v133
    v_mfma_f32_16x16x32_bf16 a[124:127], a[240:243], v[88:91], a[124:127]
    v_exp_f32 v134, v134
    v_mfma_f32_16x16x32_bf16 a[128:131], a[240:243], v[96:99], a[128:131]
    v_cvt_pk_bf16_f32 v130, v132, v133
    v_mfma_f32_16x16x32_bf16 a[132:135], a[240:243], v[104:107], a[132:135]
    v_exp_f32 v135, v135
    v_mfma_f32_16x16x32_bf16 a[136:139], a[240:243], v[112:115], a[136:139]
    ds_read_b128 a[240:243], v205 offset:128
    v_cvt_pk_bf16_f32 v131, v134, v135
    v_mfma_f32_16x16x32_bf16 a[140:143], a[244:247], v[80:83], a[140:143]
    s_add_u32 m0, s33, 25344
    v_exp_f32 v136, v136
    v_mfma_f32_16x16x32_bf16 a[144:147], a[244:247], v[88:91], a[144:147]
    buffer_load_dwordx4 v209, s[8:11], 0 offen offset:0 nt lds
    v_mfma_f32_16x16x32_bf16 a[148:151], a[244:247], v[96:99], a[148:151]
    v_exp_f32 v137, v137
    v_mfma_f32_16x16x32_bf16 a[152:155], a[244:247], v[104:107], a[152:155]
    v_exp_f32 v138, v138
    v_mfma_f32_16x16x32_bf16 a[156:159], a[244:247], v[112:115], a[156:159]
    ds_read_b128 a[244:247], v205 offset:192
    s_waitcnt lgkmcnt(2)
    v_mfma_f32_16x16x32_bf16 v[80:83], a[248:251], v[0:3], v[160:163]
    v_exp_f32 v139, v139
    v_mfma_f32_16x16x32_bf16 v[88:91], a[248:251], v[16:19], v[164:167]
    v_cvt_pk_bf16_f32 v136, v136, v137
    v_cvt_pk_bf16_f32 v137, v138, v139
    v_mfma_f32_16x16x32_bf16 v[96:99], a[248:251], v[32:35], v[168:171]
    v_exp_f32 v140, v140
    v_mfma_f32_16x16x32_bf16 v[104:107], a[248:251], v[48:51], v[172:175]
    v_exp_f32 v141, v141
    v_mfma_f32_16x16x32_bf16 v[112:115], a[248:251], v[64:67], v[176:179]
    s_add_u32 m0, s33, 25376
    ds_read_b128 a[248:251], v206 offset:0
    s_cbranch_vccnz L_p2l2
L_pbl2:
    v_mfma_f32_16x16x32_bf16 v[80:83], a[252:255], v[4:7], v[80:83]
    v_cvt_pk_bf16_f32 v138, v140, v141
    buffer_load_dwordx4 v209, s[8:11], 0 offen offset:1024 nt lds
    v_mfma_f32_16x16x32_bf16 v[88:91], a[252:255], v[20:23], v[88:91]
    v_exp_f32 v142, v142
    v_mfma_f32_16x16x32_bf16 v[96:99], a[252:255], v[36:39], v[96:99]
    v_exp_f32 v143, v143
    v_mfma_f32_16x16x32_bf16 v[104:107], a[252:255], v[52:55], v[104:107]
    v_exp_f32 v144, v144
    v_mfma_f32_16x16x32_bf16 v[112:115], a[252:255], v[68:71], v[112:115]
    ds_read_b128 a[252:255], v206 offset:64
    s_waitcnt lgkmcnt(2)
    v_mfma_f32_16x16x32_bf16 v[80:83], a[240:243], v[8:11], v[80:83]
    v_cvt_pk_bf16_f32 v139, v142, v143
    v_mfma_f32_16x16x32_bf16 v[88:91], a[240:243], v[24:27], v[88:91]
    v_exp_f32 v145, v145
    v_mfma_f32_16x16x32_bf16 v[96:99], a[240:243], v[40:43], v[96:99]
    s_add_u32 m0, s33, 25408
    v_exp_f32 v146, v146
    v_mfma_f32_16x16x32_bf16 v[104:107], a[240:243], v[56:59], v[104:107]
    v_cvt_pk_bf16_f32 v144, v144, v145
    buffer_load_dwordx4 v209, s[8:11], 0 offen offset:2048 nt lds
    v_mfma_f32_16x16x32_bf16 v[112:115], a[240:243], v[72:75], v[112:115]
    s_add_u32 m0, s33, 25440
    ds_read_b128 a[240:243], v206 offset:128
    buffer_load_dwordx4 v209, s[8:11], 0 offen offset:3072 nt lds
    v_add_u32 v209, s58, v209
    v_mfma_f32_16x16x32_bf16 v[80:83], a[244:247], v[12:15], v[80:83]
    v_exp_f32 v147, v147
    v_mfma_f32_16x16x32_bf16 v[88:91], a[244:247], v[28:31], v[88:91]
    v_exp_f32 v148, v148
    v_mfma_f32_16x16x32_bf16 v[96:99], a[244:247], v[44:47], v[96:99]
    v_exp_f32 v149, v149
    v_mfma_f32_16x16x32_bf16 v[104:107], a[244:247], v[60:63], v[104:107]
    v_cvt_pk_bf16_f32 v145, v146, v147
    v_cvt_pk_bf16_f32 v146, v148, v149
    v_mfma_f32_16x16x32_bf16 v[112:115], a[244:247], v[76:79], v[112:115]
    ds_read_b128 a[244:247], v206 offset:192
    s_waitcnt lgkmcnt(2)
    v_mfma_f32_16x16x32_bf16 v[84:87], a[248:251], v[0:3], v[160:163]
    v_exp_f32 v150, v150
    v_mfma_f32_16x16x32_bf16 v[92:95], a[248:251], v[16:19], v[164:167]
    v_exp_f32 v151, v151
    v_mfma_f32_16x16x32_bf16 v[100:103], a[248:251], v[32:35], v[168:171]
    v_cvt_pk_bf16_f32 v147, v150, v151
    v_mfma_f32_16x16x32_bf16 v[108:111], a[248:251], v[48:51], v[172:175]
    v_exp_f32 v152, v152
    v_mfma_f32_16x16x32_bf16 v[116:119], a[248:251], v[64:67], v[176:179]
    v_exp_f32 v153, v153
    v_mfma_f32_16x16x32_bf16 v[84:87], a[252:255], v[4:7], v[84:87]
    v_exp_f32 v154, v154
    v_mfma_f32_16x16x32_bf16 v[92:95], a[252:255], v[20:23], v[92:95]
    v_cvt_pk_bf16_f32 v152, v152, v153
    v_max3_f32 v234, v80, v81, v82
    v_mfma_f32_16x16x32_bf16 v[100:103], a[252:255], v[36:39], v[100:103]
    v_exp_f32 v155, v155
    v_mfma_f32_16x16x32_bf16 v[108:111], a[252:255], v[52:55], v[108:111]
    v_exp_f32 v156, v156
    v_mfma_f32_16x16x32_bf16 v[116:119], a[252:255], v[68:71], v[116:119]
    v_cvt_pk_bf16_f32 v153, v154, v155
    s_cmp_eq_u32 s34, 1
    s_cbranch_scc1 L_ewl2
    s_waitcnt vmcnt(4)
L_ewl2:
    s_waitcnt vmcnt(6) lgkmcnt(0)
    s_barrier
L_A_l3:
    v_mfma_f32_16x16x32_bf16 v[84:87], a[240:243], v[8:11], v[84:87]
    ds_read_b64_tr_b16 a[248:249], v207 offset:8448
    ds_read_b64_tr_b16 a[250:251], v207 offset:8704
    v_mfma_f32_16x16x32_bf16 v[92:95], a[240:243], v[24:27], v[92:95]
    ds_read_b64_tr_b16 a[252:253], v207 offset:8480
    ds_read_b64_tr_b16 a[254:255], v207 offset:8736
    v_mfma_f32_16x16x32_bf16 v[100:103], a[240:243], v[40:43], v[100:103]
    v_max3_f32 v235, v83, v88, v89
    v_max3_f32 v235, v235, v90, v91
    v_mfma_f32_16x16x32_bf16 v[108:111], a[240:243], v[56:59], v[108:111]
    v_exp_f32 v157, v157
    v_mfma_f32_16x16x32_bf16 v[116:119], a[240:243], v[72:75], v[116:119]
    ds_read_b64_tr_b16 a[240:241], v207 offset:8512
    ds_read_b64_tr_b16 a[242:243], v207 offset:8768
    v_mfma_f32_16x16x32_bf16 v[84:87], a[244:247], v[12:15], v[84:87]
    v_exp_f32 v158, v158
    v_mfma_f32_16x16x32_bf16 v[92:95], a[244:247], v[28:31], v[92:95]
    v_exp_f32 v159, v159
    v_mfma_f32_16x16x32_bf16 v[100:103], a[244:247], v[44:47], v[100:103]
    v_cvt_pk_bf16_f32 v154, v156, v157
    v_cvt_pk_bf16_f32 v155, v158, v159
    v_mfma_f32_16x16x32_bf16 v[108:111], a[244:247], v[60:63], v[108:111]
    v_max3_f32 v234, v234, v96, v97
    v_max3_f32 v235, v235, v98, v99
    v_mfma_f32_16x16x32_bf16 v[116:119], a[244:247], v[76:79], v[116:119]
    ds_read_b64_tr_b16 a[244:245], v207 offset:8544
    s_waitcnt lgkmcnt(5)
    v_mfma_f32_16x16x32_bf16 a[0:3], a[248:251], v[120:123], a[0:3]
    ds_read_b64_tr_b16 a[246:247], v207 offset:8800
    v_max3_f32 v234, v234, v104, v105
    v_mfma_f32_16x16x32_bf16 a[4:7], a[248:251], v[128:131], a[4:7]
    v_max3_f32 v235, v235, v106, v107
    v_max3_f32 v234, v234, v112, v113
    v_mfma_f32_16x16x32_bf16 a[8:11], a[248:251], v[136:139], a[8:11]
    v_max3_f32 v235, v235, v114, v115
    v_max3_f32 v234, v234, v84, v85
    v_mfma_f32_16x16x32_bf16 a[12:15], a[248:251], v[144:147], a[12:15]
    v_max3_f32 v235, v235, v86, v87
    v_max3_f32 v234, v234, v92, v93
    v_mfma_f32_16x16x32_bf16 a[16:19], a[248:251], v[152:155], a[16:19]
    ds_read_b64_tr_b16 a[248:249], v207 offset:8576
    s_waitcnt lgkmcnt(5)
    v_mfma_f32_16x16x32_bf16 a[20:23], a[252:255], v[120:123], a[20:23]
    ds_read_b64_tr_b16 a[250:251], v207 offset:8832
    v_max3_f32 v235, v235, v94, v95
    v_mfma_f32_16x16x32_bf16 a[24:27], a[252:255], v[128:131], a[24:27]
    v_max3_f32 v234, v234, v100, v101
    v_max3_f32 v235, v235, v102, v103
    v_mfma_f32_16x16x32_bf16 a[28:31], a[252:255], v[136:139], a[28:31]
    v_max3_f32 v234, v234, v108, v109
    v_max3_f32 v235, v235, v110, v111
    v_mfma_f32_16x16x32_bf16 a[32:35], a[252:255], v[144:147], a[32:35]
    v_max3_f32 v234, v234, v116, v117
    v_max3_f32 v235, v235, v118, v119
    v_mfma_f32_16x16x32_bf16 a[36:39], a[252:255], v[152:155], a[36:39]
    ds_read_b64_tr_b16 a[252:253], v207 offset:8608
    ds_read_b64_tr_b16 a[254:255], v207 offset:8864
    v_mfma_f32_16x16x32_bf16 v[180:183], v[200:203], v[120:123], v[180:183]
    v_max_f32 v234, v234, v235
    s_waitcnt lgkmcnt(4)
    v_mfma_f32_16x16x32_bf16 a[40:43], a[240:243], v[120:123], a[40:43]
    v_cmp_lt_f32 vcc, 0x41000000, v234
    s_cbranch_vccnz L_rrl3
L_rbl3:
    v_mfma_f32_16x16x32_bf16 a[44:47], a[240:243], v[128:131], a[44:47]
    v_exp_f32 v80, v80
    v_mfma_f32_16x16x32_bf16 a[48:51], a[240:243], v[136:139], a[48:51]
    s_add_u32 m0, s32, 0
    v_exp_f32 v81, v81
    v_mfma_f32_16x16x32_bf16 a[52:55], a[240:243], v[144:147], a[52:55]
    v_cvt_pk_bf16_f32 v80, v80, v81
    buffer_load_dwordx4 v208, s[4:7], 0 offen offset:0 nt lds
    v_mfma_f32_16x16x32_bf16 a[56:59], a[240:243], v[152:155], a[56:59]
    ds_read_b64_tr_b16 a[240:241], v207 offset:8640
    ds_read_b64_tr_b16 a[242:243], v207 offset:8896
    v_mfma_f32_16x16x32_bf16 v[184:187], v[200:203], v[128:131], v[184:187]
    v_exp_f32 v82, v82
    v_mfma_f32_16x16x32_bf16 a[60:63], a[244:247], v[120:123], a[60:63]
    v_exp_f32 v83, v83
    v_mfma_f32_16x16x32_bf16 a[64:67], a[244:247], v[128:131], a[64:67]
    s_add_u32 m0, s32, 32
    v_exp_f32 v84, v84
    v_mfma_f32_16x16x32_bf16 a[68:71], a[244:247], v[136:139], a[68:71]
    v_cvt_pk_bf16_f32 v81, v82, v83
    buffer_load_dwordx4 v208, s[4:7], 0 offen offset:1024 nt lds
    v_mfma_f32_16x16x32_bf16 a[72:75], a[244:247], v[144:147], a[72:75]
    v_exp_f32 v85, v85
    v_mfma_f32_16x16x32_bf16 a[76:79], a[244:247], v[152:155], a[76:79]
    ds_read_b64_tr_b16 a[244:245], v207 offset:8672
    ds_read_b64_tr_b16 a[246:247], v207 offset:8928
    v_mfma_f32_16x16x32_bf16 v[188:191], v[200:203], v[136:139], v[188:191]
    v_cvt_pk_bf16_f32 v82, v84, v85
    s_waitcnt lgkmcnt(4)
    v_mfma_f32_16x16x32_bf16 a[80:83], a[248:251], v[120:123], a[80:83]
    v_exp_f32 v86, v86
    v_mfma_f32_16x16x32_bf16 a[84:87], a[248:251], v[128:131], a[84:87]
    v_mfma_f32_16x16x32_bf16 a[88:91], a[248:251], v[136:139], a[88:91]
    v_exp_f32 v87, v87
    v_mfma_f32_16x16x32_bf16 a[92:95], a[248:251], v[144:147], a[92:95]
    v_exp_f32 v88, v88
    v_mfma_f32_16x16x32_bf16 a[96:99], a[248:251], v[152:155], a[96:99]
    ds_read_b128 a[248:251], v205 offset:8448
    v_cvt_pk_bf16_f32 v83, v86, v87
    v_mfma_f32_16x16x32_bf16 v[192:195], v[200:203], v[144:147], v[192:195]
    s_add_u32 m0, s32, 64
    v_exp_f32 v89, v89
    v_mfma_f32_16x16x32_bf16 a[100:103], a[252:255], v[120:123], a[100:103]
    v_cvt_pk_bf16_f32 v88, v88, v89
    buffer_load_dwordx4 v208, s[4:7], 0 offen offset:2048 nt lds
    v_mfma_f32_16x16x32_bf16 a[104:107], a[252:255], v[128:131], a[104:107]
    v_exp_f32 v90, v90
    v_mfma_f32_16x16x32_bf16 a[108:111], a[252:255], v[136:139], a[108:111]
    s_add_u32 m0, s32, 96
    v_exp_f32 v91, v91
    v_mfma_f32_16x16x32_bf16 a[112:115], a[252:255], v[144:147], a[112:115]
    v_cvt_pk_bf16_f32 v89, v90, v91
    buffer_load_dwordx4 v208, s[4:7], 0 offen offset:3072 nt lds
    v_add_u32 v208, s58, v208
    v_mfma_f32_16x16x32_bf16 a[116:119], a[252:255], v[152:155], a[116:119]
    v_exp_f32 v92, v92
    v_mfma_f32_16x16x32_bf16 v[196:199], v[200:203], v[152:155], v[196:199]
    ds_read_b128 a[252:255], v205 offset:8512
    s_waitcnt lgkmcnt(2)
    v_mfma_f32_16x16x32_bf16 a[120:123], a[240:243], v[120:123], a[120:123]
    v_exp_f32 v93, v93
    v_mfma_f32_16x16x32_bf16 a[124:127], a[240:243], v[128:131], a[124:127]
    v_exp_f32 v94, v94
    v_mfma_f32_16x16x32_bf16 a[128:131], a[240:243], v[136:139], a[128:131]
    v_cvt_pk_bf16_f32 v90, v92, v93
    v_mfma_f32_16x16x32_bf16 a[132:135], a[240:243], v[144:147], a[132:135]
    v_exp_f32 v95, v95
    v_mfma_f32_16x16x32_bf16 a[136:139], a[240:243], v[152:155], a[136:139]
    ds_read_b128 a[240:243], v205 offset:8576
    v_cvt_pk_bf16_f32 v91, v94, v95
    v_mfma_f32_16x16x32_bf16 a[140:143], a[244:247], v[120:123], a[140:143]
    s_add_u32 m0, s33, 0
    v_exp_f32 v96, v96
    v_mfma_f32_16x16x32_bf16 a[144:147], a[244:247], v[128:131], a[144:147]
    buffer_load_dwordx4 v209, s[8:11], 0 offen offset:0 nt lds
    v_mfma_f32_16x16x32_bf16 a[148:151], a[244:247], v[136:139], a[148:151]
    v_exp_f32 v97, v97
    v_mfma_f32_16x16x32_bf16 a[152:155], a[244:247], v[144:147], a[152:155]
    v_exp_f32 v98, v98
    v_mfma_f32_16x16x32_bf16 a[156:159], a[244:247], v[152:155], a[156:159]
    ds_read_b128 a[244:247], v205 offset:8640
    s_waitcnt lgkmcnt(2)
    v_mfma_f32_16x16x32_bf16 v[120:123], a[248:251], v[0:3], v[160:163]
    v_exp_f32 v99, v99
    v_mfma_f32_16x16x32_bf16 v[128:131], a[248:251], v[16:19], v[164:167]
    v_cvt_pk_bf16_f32 v96, v96, v97
    v_cvt_pk_bf16_f32 v97, v98, v99
    v_mfma_f32_16x16x32_bf16 v[136:139], a[248:251], v[32:35], v[168:171]
    v_exp_f32 v100, v100
    v_mfma_f32_16x16x32_bf16 v[144:147], a[248:251], v[48:51], v[172:175]
    v_exp_f32 v101, v101
    v_mfma_f32_16x16x32_bf16 v[152:155], a[248:251], v[64:67], v[176:179]
    s_add_u32 m0, s33, 32
    ds_read_b128 a[248:251], v206 offset:8448
    s_cbranch_vccnz L_p2l3
L_pbl3:
    v_mfma_f32_16x16x32_bf16 v[120:123], a[252:255], v[4:7], v[120:123]
    v_cvt_pk_bf16_f32 v98, v100, v101
    buffer_load_dwordx4 v209, s[8:11], 0 offen offset:1024 nt lds
    v_mfma_f32_16x16x32_bf16 v[128:131], a[252:255], v[20:23], v[128:131]
    v_exp_f32 v102, v102
    v_mfma_f32_16x16x32_bf16 v[136:139], a[252:255], v[36:39], v[136:139]
    v_exp_f32 v103, v103
    v_mfma_f32_16x16x32_bf16 v[144:147], a[252:255], v[52:55], v[144:147]
    v_exp_f32 v104, v104
    v_mfma_f32_16x16x32_bf16 v[152:155], a[252:255], v[68:71], v[152:155]
    ds_read_b128 a[252:255], v206 offset:8512
    s_waitcnt lgkmcnt(2)
    v_mfma_f32_16x16x32_bf16 v[120:123], a[240:243], v[8:11], v[120:123]
    v_cvt_pk_bf16_f32 v99, v102, v103
    v_mfma_f32_16x16x32_bf16 v[128:131], a[240:243], v[24:27], v[128:131]
    v_exp_f32 v105, v105
    v_mfma_f32_16x16x32_bf16 v[136:139], a[240:243], v[40:43], v[136:139]
    s_add_u32 m0, s33, 64
    v_exp_f32 v106, v106
    v_mfma_f32_16x16x32_bf16 v[144:147], a[240:243], v[56:59], v[144:147]
    v_cvt_pk_bf16_f32 v104, v104, v105
    buffer_load_dwordx4 v209, s[8:11], 0 offen offset:2048 nt lds
    v_mfma_f32_16x16x32_bf16 v[152:155], a[240:243], v[72:75], v[152:155]
    s_add_u32 m0, s33, 96
    ds_read_b128 a[240:243], v206 offset:8576
    buffer_load_dwordx4 v209, s[8:11], 0 offen offset:3072 nt lds
    v_add_u32 v209, s58, v209
    v_mfma_f32_16x16x32_bf16 v[120:123], a[244:247], v[12:15], v[120:123]
    v_exp_f32 v107, v107
    v_mfma_f32_16x16x32_bf16 v[128:131], a[244:247], v[28:31], v[128:131]
    v_exp_f32 v108, v108
    v_mfma_f32_16x16x32_bf16 v[136:139], a[244:247], v[44:47], v[136:139]
    v_exp_f32 v109, v109
    v_mfma_f32_16x16x32_bf16 v[144:147], a[244:247], v[60:63], v[144:147]
    v_cvt_pk_bf16_f32 v105, v106, v107
    v_cvt_pk_bf16_f32 v106, v108, v109
    v_mfma_f32_16x16x32_bf16 v[152:155], a[244:247], v[76:79], v[152:155]
    ds_read_b128 a[244:247], v206 offset:8640
    s_waitcnt lgkmcnt(2)
    v_mfma_f32_16x16x32_bf16 v[124:127], a[248:251], v[0:3], v[160:163]
    v_exp_f32 v110, v110
    v_mfma_f32_16x16x32_bf16 v[132:135], a[248:251], v[16:19], v[164:167]
    v_exp_f32 v111, v111
    v_mfma_f32_16x16x32_bf16 v[140:143], a[248:251], v[32:35], v[168:171]
    v_cvt_pk_bf16_f32 v107, v110, v111
    v_mfma_f32_16x16x32_bf16 v[148:151], a[248:251], v[48:51], v[172:175]
    v_exp_f32 v112, v112
    v_mfma_f32_16x16x32_bf16 v[156:159], a[248:251], v[64:67], v[176:179]
    v_exp_f32 v113, v113
    v_mfma_f32_16x16x32_bf16 v[124:127], a[252:255], v[4:7], v[124:127]
    v_exp_f32 v114, v114
    v_mfma_f32_16x16x32_bf16 v[132:135], a[252:255], v[20:23], v[132:135]
    v_cvt_pk_bf16_f32 v112, v112, v113
    v_max3_f32 v234, v120, v121, v122
    v_mfma_f32_16x16x32_bf16 v[140:143], a[252:255], v[36:39], v[140:143]
    v_exp_f32 v115, v115
    v_mfma_f32_16x16x32_bf16 v[148:151], a[252:255], v[52:55], v[148:151]
    v_exp_f32 v116, v116
    v_mfma_f32_16x16x32_bf16 v[156:159], a[252:255], v[68:71], v[156:159]
    v_cvt_pk_bf16_f32 v113, v114, v115
    s_cmp_eq_u32 s34, 1
    s_cbranch_scc1 L_ewl3
    s_waitcnt vmcnt(4)
L_ewl3:
    s_waitcnt vmcnt(6) lgkmcnt(0)
    s_barrier
L_A_l0:
    v_mfma_f32_16x16x32_bf16 v[124:127], a[240:243], v[8:11], v[124:127]
    ds_read_b64_tr_b16 a[248:249], v207 offset:16896
    ds_read_b64_tr_b16 a[250:251], v207 offset:17152
    v_mfma_f32_16x16x32_bf16 v[132:135], a[240:243], v[24:27], v[132:135]
    ds_read_b64_tr_b16 a[252:253], v207 offset:16928
    ds_read_b64_tr_b16 a[254:255], v207 offset:17184
    v_mfma_f32_16x16x32_bf16 v[140:143], a[240:243], v[40:43], v[140:143]
    v_max3_f32 v235, v123, v128, v129
    v_max3_f32 v235, v235, v130, v131
    v_mfma_f32_16x16x32_bf16 v[148:151], a[240:243], v[56:59], v[148:151]
    v_exp_f32 v117, v117
    v_mfma_f32_16x16x32_bf16 v[156:159], a[240:243], v[72:75], v[156:159]
    ds_read_b64_tr_b16 a[240:241], v207 offset:16960
    ds_read_b64_tr_b16 a[242:243], v207 offset:17216
    v_mfma_f32_16x16x32_bf16 v[124:127], a[244:247], v[12:15], v[124:127]
    v_exp_f32 v118, v118
    v_mfma_f32_16x16x32_bf16 v[132:135], a[244:247], v[28:31], v[132:135]
    v_exp_f32 v119, v119
    v_mfma_f32_16x16x32_bf16 v[140:143], a[244:247], v[44:47], v[140:143]
    v_cvt_pk_bf16_f32 v114, v116, v117
    v_cvt_pk_bf16_f32 v115, v118, v119
    v_mfma_f32_16x16x32_bf16 v[148:151], a[244:247], v[60:63], v[148:151]
    v_max3_f32 v234, v234, v136, v137
    v_max3_f32 v235, v235, v138, v139
    v_mfma_f32_16x16x32_bf16 v[156:159], a[244:247], v[76:79], v[156:159]
    ds_read_b64_tr_b16 a[244:245], v207 offset:16992
    s_waitcnt lgkmcnt(5)
    v_mfma_f32_16x16x32_bf16 a[0:3], a[248:251], v[80:83], a[0:3]
    ds_read_b64_tr_b16 a[246:247], v207 offset:17248
    v_max3_f32 v234, v234, v144, v145
    v_mfma_f32_16x16x32_bf16 a[4:7], a[248:251], v[88:91], a[4:7]
    v_max3_f32 v235, v235, v146, v147
    v_max3_f32 v234, v234, v152, v153
    v_mfma_f32_16x16x32_bf16 a[8:11], a[248:251], v[96:99], a[8:11]
    v_max3_f32 v235, v235, v154, v155
    v_max3_f32 v234, v234, v124, v125
    v_mfma_f32_16x16x32_bf16 a[12:15], a[248:251], v[104:107], a[12:15]
    v_max3_f32 v235, v235, v126, v127
    v_max3_f32 v234, v234, v132, v133
    v_mfma_f32_16x16x32_bf16 a[16:19], a[248:251], v[112:115], a[16:19]
    ds_read_b64_tr_b16 a[248:249], v207 offset:17024
    s_waitcnt lgkmcnt(5)
    v_mfma_f32_16x16x32_bf16 a[20:23], a[252:255], v[80:83], a[20:23]
    ds_read_b64_tr_b16 a[250:251], v207 offset:17280
    v_max3_f32 v235, v235, v134, v135
    v_mfma_f32_16x16x32_bf16 a[24:27], a[252:255], v[88:91], a[24:27]
    v_max3_f32 v234, v234, v140, v141
    v_max3_f32 v235, v235, v142, v143
    v_mfma_f32_16x16x32_bf16 a[28:31], a[252:255], v[96:99], a[28:31]
    v_max3_f32 v234, v234, v148, v149
    v_max3_f32 v235, v235, v150, v151
    v_mfma_f32_16x16x32_bf16 a[32:35], a[252:255], v[104:107], a[32:35]
    v_max3_f32 v234, v234, v156, v157
    v_max3_f32 v235, v235, v158, v159
    v_mfma_f32_16x16x32_bf16 a[36:39], a[252:255], v[112:115], a[36:39]
    ds_read_b64_tr_b16 a[252:253], v207 offset:17056
    ds_read_b64_tr_b16 a[254:255], v207 offset:17312
    v_mfma_f32_16x16x32_bf16 v[180:183], v[200:203], v[80:83], v[180:183]
    v_max_f32 v234, v234, v235
    s_waitcnt lgkmcnt(4)
    v_mfma_f32_16x16x32_bf16 a[40:43], a[240:243], v[80:83], a[40:43]
    v_cmp_lt_f32 vcc, 0x41000000, v234
    s_cbranch_vccnz L_rrl0
L_rbl0:
    v_mfma_f32_16x16x32_bf16 a[44:47], a[240:243], v[88:91], a[44:47]
    v_exp_f32 v120, v120
    v_mfma_f32_16x16x32_bf16 a[48:51], a[240:243], v[96:99], a[48:51]
    s_add_u32 m0, s32, 8448
    v_exp_f32 v121, v121
    v_mfma_f32_16x16x32_bf16 a[52:55], a[240:243], v[104:107], a[52:55]
    v_cvt_pk_bf16_f32 v120, v120, v121
    buffer_load_dwordx4 v208, s[4:7], 0 offen offset:0 nt lds
    v_mfma_f32_16x16x32_bf16 a[56:59], a[240:243], v[112:115], a[56:59]
    ds_read_b64_tr_b16 a[240:241], v207 offset:17088
    ds_read_b64_tr_b16 a[242:243], v207 offset:17344
    v_mfma_f32_16x16x32_bf16 v[184:187], v[200:203], v[88:91], v[184:187]
    v_exp_f32 v122, v122
    v_mfma_f32_16x16x32_bf16 a[60:63], a[244:247], v[80:83], a[60:63]
    v_exp_f32 v123, v123
    v_mfma_f32_16x16x32_bf16 a[64:67], a[244:247], v[88:91], a[64:67]
    s_add_u32 m0, s32, 8480
    v_exp_f32 v124, v124
    v_mfma_f32_16x16x32_bf16 a[68:71], a[244:247], v[96:99], a[68:71]
    v_cvt_pk_bf16_f32 v121, v122, v123
    buffer_load_dwordx4 v208, s[4:7], 0 offen offset:1024 nt lds
    v_mfma_f32_16x16x32_bf16 a[72:75], a[244:247], v[104:107], a[72:75]
    v_exp_f32 v125, v125
    v_mfma_f32_16x16x32_bf16 a[76:79], a[244:247], v[112:115], a[76:79]
    ds_read_b64_tr_b16 a[244:245], v207 offset:17120
    ds_read_b64_tr_b16 a[246:247], v207 offset:17376
    v_mfma_f32_16x16x32_bf16 v[188:191], v[200:203], v[96:99], v[188:191]
    v_cvt_pk_bf16_f32 v122, v124, v125
    s_waitcnt lgkmcnt(4)
    v_mfma_f32_16x16x32_bf16 a[80:83], a[248:251], v[80:83], a[80:83]
    v_exp_f32 v126, v126
    v_mfma_f32_16x16x32_bf16 a[84:87], a[248:251], v[88:91], a[84:87]
    v_mfma_f32_16x16x32_bf16 a[88:91], a[248:251], v[96:99], a[88:91]
    v_exp_f32 v127, v127
    v_mfma_f32_16x16x32_bf16 a[92:95], a[248:251], v[104:107], a[92:95]
    v_exp_f32 v128, v128
    v_mfma_f32_16x16x32_bf16 a[96:99], a[248:251], v[112:115], a[96:99]
    ds_read_b128 a[248:251], v205 offset:16896
    v_cvt_pk_bf16_f32 v123, v126, v127
    v_mfma_f32_16x16x32_bf16 v[192:195], v[200:203], v[104:107], v[192:195]
    s_add_u32 m0, s32, 8512
    v_exp_f32 v129, v129
    v_mfma_f32_16x16x32_bf16 a[100:103], a[252:255], v[80:83], a[100:103]
    v_cvt_pk_bf16_f32 v128, v128, v129
    buffer_load_dwordx4 v208, s[4:7], 0 offen offset:2048 nt lds
    v_mfma_f32_16x16x32_bf16 a[104:107], a[252:255], v[88:91], a[104:107]
    v_exp_f32 v130, v130
    v_mfma_f32_16x16x32_bf16 a[108:111], a[252:255], v[96:99], a[108:111]
    s_add_u32 m0, s32, 8544
    v_exp_f32 v131, v131
    v_mfma_f32_16x16x32_bf16 a[112:115], a[252:255], v[104:107], a[112:115]
    v_cvt_pk_bf16_f32 v129, v130, v131
    buffer_load_dwordx4 v208, s[4:7], 0 offen offset:3072 nt lds
    v_add_u32 v208, s58, v208
    v_mfma_f32_16x16x32_bf16 a[116:119], a[252:255], v[112:115], a[116:119]
    v_exp_f32 v132, v132
    v_mfma_f32_16x16x32_bf16 v[196:199], v[200:203], v[112:115], v[196:199]
    ds_read_b128 a[252:255], v205 offset:16960
    s_waitcnt lgkmcnt(2)
    v_mfma_f32_16x16x32_bf16 a[120:123], a[240:243], v[80:83], a[120:123]
    v_exp_f32 v133, v133
    v_mfma_f32_16x16x32_bf16 a[124:127], a[240:243], v[88:91], a[124:127]
    v_exp_f32 v134, v134
    v_mfma_f32_16x16x32_bf16 a[128:131], a[240:243], v[96:99], a[128:131]
    v_cvt_pk_bf16_f32 v130, v132, v133
    v_mfma_f32_16x16x32_bf16 a[132:135], a[240:243], v[104:107], a[132:135]
    v_exp_f32 v135, v135
    v_mfma_f32_16x16x32_bf16 a[136:139], a[240:243], v[112:115], a[136:139]
    ds_read_b128 a[240:243], v205 offset:17024
    v_cvt_pk_bf16_f32 v131, v134, v135
    v_mfma_f32_16x16x32_bf16 a[140:143], a[244:247], v[80:83], a[140:143]
    s_add_u32 m0, s33, 8448
    v_exp_f32 v136, v136
    v_mfma_f32_16x16x32_bf16 a[144:147], a[244:247], v[88:91], a[144:147]
    buffer_load_dwordx4 v209, s[8:11], 0 offen offset:0 nt lds
    v_mfma_f32_16x16x32_bf16 a[148:151], a[244:247], v[96:99], a[148:151]
    v_exp_f32 v137, v137
    v_mfma_f32_16x16x32_bf16 a[152:155], a[244:247], v[104:107], a[152:155]
    v_exp_f32 v138, v138
    v_mfma_f32_16x16x32_bf16 a[156:159], a[244:247], v[112:115], a[156:159]
    ds_read_b128 a[244:247], v205 offset:17088
    s_waitcnt lgkmcnt(2)
    v_mfma_f32_16x16x32_bf16 v[80:83], a[248:251], v[0:3], v[160:163]
    v_exp_f32 v139, v139
    v_mfma_f32_16x16x32_bf16 v[88:91], a[248:251], v[16:19], v[164:167]
    v_cvt_pk_bf16_f32 v136, v136, v137
    v_cvt_pk_bf16_f32 v137, v138, v139
    v_mfma_f32_16x16x32_bf16 v[96:99], a[248:251], v[32:35], v[168:171]
    v_exp_f32 v140, v140
    v_mfma_f32_16x16x32_bf16 v[104:107], a[248:251], v[48:51], v[172:175]
    v_exp_f32 v141, v141
    v_mfma_f32_16x16x32_bf16 v[112:115], a[248:251], v[64:67], v[176:179]
    s_add_u32 m0, s33, 8480
    ds_read_b128 a[248:251], v206 offset:16896
    s_cbranch_vccnz L_p2l0
L_pbl0:
    v_mfma_f32_16x16x32_bf16 v[80:83], a[252:255], v[4:7], v[80:83]
    v_cvt_pk_bf16_f32 v138, v140, v141
    buffer_load_dwordx4 v209, s[8:11], 0 offen offset:1024 nt lds
    v_mfma_f32_16x16x32_bf16 v[88:91], a[252:255], v[20:23], v[88:91]
    v_exp_f32 v142, v142
    v_mfma_f32_16x16x32_bf16 v[96:99], a[252:255], v[36:39], v[96:99]
    v_exp_f32 v143, v143
    v_mfma_f32_16x16x32_bf16 v[104:107], a[252:255], v[52:55], v[104:107]
    v_exp_f32 v144, v144
    v_mfma_f32_16x16x32_bf16 v[112:115], a[252:255], v[68:71], v[112:115]
    ds_read_b128 a[252:255], v206 offset:16960
    s_waitcnt lgkmcnt(2)
    v_mfma_f32_16x16x32_bf16 v[80:83], a[240:243], v[8:11], v[80:83]
    v_cvt_pk_bf16_f32 v139, v142, v143
    v_mfma_f32_16x16x32_bf16 v[88:91], a[240:243], v[24:27], v[88:91]
    v_exp_f32 v145, v145
    v_mfma_f32_16x16x32_bf16 v[96:99], a[240:243], v[40:43], v[96:99]
    s_add_u32 m0, s33, 8512
    v_exp_f32 v146, v146
    v_mfma_f32_16x16x32_bf16 v[104:107], a[240:243], v[56:59], v[104:107]
    v_cvt_pk_bf16_f32 v144, v144, v145
    buffer_load_dwordx4 v209, s[8:11], 0 offen offset:2048 nt lds
    v_mfma_f32_16x16x32_bf16 v[112:115], a[240:243], v[72:75], v[112:115]
    s_add_u32 m0, s33, 8544
    ds_read_b128 a[240:243], v206 offset:17024
    buffer_load_dwordx4 v209, s[8:11], 0 offen offset:3072 nt lds
    v_add_u32 v209, s58, v209
    v_mfma_f32_16x16x32_bf16 v[80:83], a[244:247], v[12:15], v[80:83]
    v_exp_f32 v147, v147
    v_mfma_f32_16x16x32_bf16 v[88:91], a[244:247], v[28:31], v[88:91]
    v_exp_f32 v148, v148
    v_mfma_f32_16x16x32_bf16 v[96:99], a[244:247], v[44:47], v[96:99]
    v_exp_f32 v149, v149
    v_mfma_f32_16x16x32_bf16 v[104:107], a[244:247], v[60:63], v[104:107]
    v_cvt_pk_bf16_f32 v145, v146, v147
    v_cvt_pk_bf16_f32 v146, v148, v149
    v_mfma_f32_16x16x32_bf16 v[112:115], a[244:247], v[76:79], v[112:115]
    ds_read_b128 a[244:247], v206 offset:17088
    s_waitcnt lgkmcnt(2)
    v_mfma_f32_16x16x32_bf16 v[84:87], a[248:251], v[0:3], v[160:163]
    v_exp_f32 v150, v150
    v_mfma_f32_16x16x32_bf16 v[92:95], a[248:251], v[16:19], v[164:167]
    v_exp_f32 v151, v151
    v_mfma_f32_16x16x32_bf16 v[100:103], a[248:251], v[32:35], v[168:171]
    v_cvt_pk_bf16_f32 v147, v150, v151
    v_mfma_f32_16x16x32_bf16 v[108:111], a[248:251], v[48:51], v[172:175]
    v_exp_f32 v152, v152
    v_mfma_f32_16x16x32_bf16 v[116:119], a[248:251], v[64:67], v[176:179]
    v_exp_f32 v153, v153
    v_mfma_f32_16x16x32_bf16 v[84:87], a[252:255], v[4:7], v[84:87]
    v_exp_f32 v154, v154
    v_mfma_f32_16x16x32_bf16 v[92:95], a[252:255], v[20:23], v[92:95]
    v_cvt_pk_bf16_f32 v152, v152, v153
    v_max3_f32 v234, v80, v81, v82
    v_mfma_f32_16x16x32_bf16 v[100:103], a[252:255], v[36:39], v[100:103]
    v_exp_f32 v155, v155
    v_mfma_f32_16x16x32_bf16 v[108:111], a[252:255], v[52:55], v[108:111]
    v_exp_f32 v156, v156
    v_mfma_f32_16x16x32_bf16 v[116:119], a[252:255], v[68:71], v[116:119]
    v_cvt_pk_bf16_f32 v153, v154, v155
    s_cmp_eq_u32 s34, 1
    s_cbranch_scc1 L_ewl0
    s_waitcnt vmcnt(4)
L_ewl0:
    s_waitcnt vmcnt(6) lgkmcnt(0)
    s_add_u32 s31, s31, 1
    s_cmp_lt_u32 s31, 3
    s_barrier
    s_cbranch_scc1 L_A_l1
L_A_e13:
    v_mfma_f32_16x16x32_bf16 v[84:87], a[240:243], v[8:11], v[84:87]
    ds_read_b64_tr_b16 a[248:249], v207 offset:25344
    ds_read_b64_tr_b16 a[250:251], v207 offset:25600
    v_mfma_f32_16x16x32_bf16 v[92:95], a[240:243], v[24:27], v[92:95]
    ds_read_b64_tr_b16 a[252:253], v207 offset:25376
    ds_read_b64_tr_b16 a[254:255], v207 offset:25632
    v_mfma_f32_16x16x32_bf16 v[100:103], a[240:243], v[40:43], v[100:103]
    v_max3_f32 v235, v83, v88, v89
    v_max3_f32 v235, v235, v90, v91
    v_mfma_f32_16x16x32_bf16 v[108:111], a[240:243], v[56:59], v[108:111]
    v_exp_f32 v157, v157
    v_mfma_f32_16x16x32_bf16 v[116:119], a[240:243], v[72:75], v[116:119]
    ds_read_b64_tr_b16 a[240:241], v207 offset:25408
    ds_read_b64_tr_b16 a[242:243], v207 offset:25664
    v_mfma_f32_16x16x32_bf16 v[84:87], a[244:247], v[12:15], v[84:87]
    v_exp_f32 v158, v158
    v_mfma_f32_16x16x32_bf16 v[92:95], a[244:247], v[28:31], v[92:95]
    v_exp_f32 v159, v159
    v_mfma_f32_16x16x32_bf16 v[100:103], a[244:247], v[44:47], v[100:103]
    v_cvt_pk_bf16_f32 v154, v156, v157
    v_cvt_pk_bf16_f32 v155, v158, v159
    v_mfma_f32_16x16x32_bf16 v[108:111], a[244:247], v[60:63], v[108:111]
    v_max3_f32 v234, v234, v96, v97
    v_max3_f32 v235, v235, v98, v99
    v_mfma_f32_16x16x32_bf16 v[116:119], a[244:247], v[76:79], v[116:119]
    ds_read_b64_tr_b16 a[244:245], v207 offset:25440
    s_waitcnt lgkmcnt(5)
    v_mfma_f32_16x16x32_bf16 a[0:3], a[248:251], v[120:123], a[0:3]
    ds_read_b64_tr_b16 a[246:247], v207 offset:25696
    v_max3_f32 v234, v234, v104, v105
    v_mfma_f32_16x16x32_bf16 a[4:7], a[248:251], v[128:131], a[4:7]
    v_max3_f32 v235, v235, v106, v107
    v_max3_f32 v234, v234, v112, v113
    v_mfma_f32_16x16x32_bf16 a[8:11], a[248:251], v[136:139], a[8:11]
    v_max3_f32 v235, v235, v114, v115
    v_max3_f32 v234, v234, v84, v85
    v_mfma_f32_16x16x32_bf16 a[12:15], a[248:251], v[144:147], a[12:15]
    v_max3_f32 v235, v235, v86, v87
    v_max3_f32 v234, v234, v92, v93
    v_mfma_f32_16x16x32_bf16 a[16:19], a[248:251], v[152:155], a[16:19]
    ds_read_b64_tr_b16 a[248:249], v207 offset:25472
    s_waitcnt lgkmcnt(5)
    v_mfma_f32_16x16x32_bf16 a[20:23], a[252:255], v[120:123], a[20:23]
    ds_read_b64_tr_b16 a[250:251], v207 offset:25728
    v_max3_f32 v235, v235, v94, v95
    v_mfma_f32_16x16x32_bf16 a[24:27], a[252:255], v[128:131], a[24:27]
    v_max3_f32 v234, v234, v100, v101
    v_max3_f32 v235, v235, v102, v103
    v_mfma_f32_16x16x32_bf16 a[28:31], a[252:255], v[136:139], a[28:31]
    v_max3_f32 v234, v234, v108, v109
    v_max3_f32 v235, v235, v110, v111
    v_mfma_f32_16x16x32_bf16 a[32:35], a[252:255], v[144:147], a[32:35]
    v_max3_f32 v234, v234, v116, v117
    v_max3_f32 v235, v235, v118, v119
    v_mfma_f32_16x16x32_bf16 a[36:39], a[252:255], v[152:155], a[36:39]
    ds_read_b64_tr_b16 a[252:253], v207 offset:25504
    ds_read_b64_tr_b16 a[254:255], v207 offset:25760
    v_mfma_f32_16x16x32_bf16 v[180:183], v[200:203], v[120:123], v[180:183]
    v_max_f32 v234, v234, v235
    s_waitcnt lgkmcnt(4)
    v_mfma_f32_16x16x32_bf16 a[40:43], a[240:243], v[120:123], a[40:43]
    v_cmp_lt_f32 vcc, 0x41000000, v234
    s_cbranch_vccnz L_rre13
L_rbe13:
    v_mfma_f32_16x16x32_bf16 a[44:47], a[240:243], v[128:131], a[44:47]
    v_exp_f32 v80, v80
    v_mfma_f32_16x16x32_bf16 a[48:51], a[240:243], v[136:139], a[48:51]
    v_exp_f32 v81, v81
    v_mfma_f32_16x16x32_bf16 a[52:55], a[240:243], v[144:147], a[52:55]
    v_cvt_pk_bf16_f32 v80, v80, v81
    v_mfma_f32_16x16x32_bf16 a[56:59], a[240:243], v[152:155], a[56:59]
    ds_read_b64_tr_b16 a[240:241], v207 offset:25536
    ds_read_b64_tr_b16 a[242:243], v207 offset:25792
    v_mfma_f32_16x16x32_bf16 v[184:187], v[200:203], v[128:131], v[184:187]
    v_exp_f32 v82, v82
    v_mfma_f32_16x16x32_bf16 a[60:63], a[244:247], v[120:123], a[60:63]
    v_exp_f32 v83, v83
    v_mfma_f32_16x16x32_bf16 a[64:67], a[244:247], v[128:131], a[64:67]
    v_exp_f32 v84, v84
    v_mfma_f32_16x16x32_bf16 a[68:71], a[244:247], v[136:139], a[68:71]
    v_cvt_pk_bf16_f32 v81, v82, v83
    v_mfma_f32_16x16x32_bf16 a[72:75], a[244:247], v[144:147], a[72:75]
    v_exp_f32 v85, v85
    v_mfma_f32_16x16x32_bf16 a[76:79], a[244:247], v[152:155], a[76:79]
    ds_read_b64_tr_b16 a[244:245], v207 offset:25568
    ds_read_b64_tr_b16 a[246:247], v207 offset:25824
    v_mfma_f32_16x16x32_bf16 v[188:191], v[200:203], v[136:139], v[188:191]
    v_cvt_pk_bf16_f32 v82, v84, v85
    s_waitcnt lgkmcnt(4)
    v_mfma_f32_16x16x32_bf16 a[80:83], a[248:251], v[120:123], a[80:83]
    v_exp_f32 v86, v86
    v_mfma_f32_16x16x32_bf16 a[84:87], a[248:251], v[128:131], a[84:87]
    v_mfma_f32_16x16x32_bf16 a[88:91], a[248:251], v[136:139], a[88:91]
    v_exp_f32 v87, v87
    v_mfma_f32_16x16x32_bf16 a[92:95], a[248:251], v[144:147], a[92:95]
    v_exp_f32 v88, v88
    v_mfma_f32_16x16x32_bf16 a[96:99], a[248:251], v[152:155], a[96:99]
    ds_read_b128 a[248:251], v205 offset:25344
    v_cvt_pk_bf16_f32 v83, v86, v87
    v_mfma_f32_16x16x32_bf16 v[192:195], v[200:203], v[144:147], v[192:195]
    v_exp_f32 v89, v89
    v_mfma_f32_16x16x32_bf16 a[100:103], a[252:255], v[120:123], a[100:103]
    v_cvt_pk_bf16_f32 v88, v88, v89
    v_mfma_f32_16x16x32_bf16 a[104:107], a[252:255], v[128:131], a[104:107]
    v_exp_f32 v90, v90
    v_mfma_f32_16x16x32_bf16 a[108:111], a[252:255], v[136:139], a[108:111]
    v_exp_f32 v91, v91
    v_mfma_f32_16x16x32_bf16 a[112:115], a[252:255], v[144:147], a[112:115]
    v_cvt_pk_bf16_f32 v89, v90, v91
    v_mfma_f32_16x16x32_bf16 a[116:119], a[252:255], v[152:155], a[116:119]
    v_exp_f32 v92, v92
    v_mfma_f32_16x16x32_bf16 v[196:199], v[200:203], v[152:155], v[196:199]
    ds_read_b128 a[252:255], v205 offset:25408
    s_waitcnt lgkmcnt(2)
    v_mfma_f32_16x16x32_bf16 a[120:123], a[240:243], v[120:123], a[120:123]
    v_exp_f32 v93, v93
    v_mfma_f32_16x16x32_bf16 a[124:127], a[240:243], v[128:131], a[124:127]
    v_exp_f32 v94, v94
    v_mfma_f32_16x16x32_bf16 a[128:131], a[240:243], v[136:139], a[128:131]
    v_cvt_pk_bf16_f32 v90, v92, v93
    v_mfma_f32_16x16x32_bf16 a[132:135], a[240:243], v[144:147], a[132:135]
    v_exp_f32 v95, v95
    v_mfma_f32_16x16x32_bf16 a[136:139], a[240:243], v[152:155], a[136:139]
    ds_read_b128 a[240:243], v205 offset:25472
    v_cvt_pk_bf16_f32 v91, v94, v95
    v_mfma_f32_16x16x32_bf16 a[140:143], a[244:247], v[120:123], a[140:143]
    v_exp_f32 v96, v96
    v_mfma_f32_16x16x32_bf16 a[144:147], a[244:247], v[128:131], a[144:147]
    v_mfma_f32_16x16x32_bf16 a[148:151], a[244:247], v[136:139], a[148:151]
    v_exp_f32 v97, v97
    v_mfma_f32_16x16x32_bf16 a[152:155], a[244:247], v[144:147], a[152:155]
    v_exp_f32 v98, v98
    v_mfma_f32_16x16x32_bf16 a[156:159], a[244:247], v[152:155], a[156:159]
    ds_read_b128 a[244:247], v205 offset:25536
    s_waitcnt lgkmcnt(2)
    v_mfma_f32_16x16x32_bf16 v[120:123], a[248:251], v[0:3], v[160:163]
    v_exp_f32 v99, v99
    v_mfma_f32_16x16x32_bf16 v[128:131], a[248:251], v[16:19], v[164:167]
    v_cvt_pk_bf16_f32 v96, v96, v97
    v_cvt_pk_bf16_f32 v97, v98, v99
    v_mfma_f32_16x16x32_bf16 v[136:139], a[248:251], v[32:35], v[168:171]
    v_exp_f32 v100, v100
    v_mfma_f32_16x16x32_bf16 v[144:147], a[248:251], v[48:51], v[172:175]
    v_exp_f32 v101, v101
    v_mfma_f32_16x16x32_bf16 v[152:155], a[248:251], v[64:67], v[176:179]
    ds_read_b128 a[248:251], v206 offset:25344
    s_cbranch_vccnz L_p2e13
L_pbe13:
    v_mfma_f32_16x16x32_bf16 v[120:123], a[252:255], v[4:7], v[120:123]
    v_cvt_pk_bf16_f32 v98, v100, v101
    v_mfma_f32_16x16x32_bf16 v[128:131], a[252:255], v[20:23], v[128:131]
    v_exp_f32 v102, v102
    v_mfma_f32_16x16x32_bf16 v[136:139], a[252:255], v[36:39], v[136:139]
    v_exp_f32 v103, v103
    v_mfma_f32_16x16x32_bf16 v[144:147], a[252:255], v[52:55], v[144:147]
    v_exp_f32 v104, v104
    v_mfma_f32_16x16x32_bf16 v[152:155], a[252:255], v[68:71], v[152:155]
    ds_read_b128 a[252:255], v206 offset:25408
    s_waitcnt lgkmcnt(2)
    v_mfma_f32_16x16x32_bf16 v[120:123], a[240:243], v[8:11], v[120:123]
    v_cvt_pk_bf16_f32 v99, v102, v103
    v_mfma_f32_16x16x32_bf16 v[128:131], a[240:243], v[24:27], v[128:131]
    v_exp_f32 v105, v105
    v_mfma_f32_16x16x32_bf16 v[136:139], a[240:243], v[40:43], v[136:139]
    v_exp_f32 v106, v106
    v_mfma_f32_16x16x32_bf16 v[144:147], a[240:243], v[56:59], v[144:147]
    v_cvt_pk_bf16_f32 v104, v104, v105
    v_mfma_f32_16x16x32_bf16 v[152:155], a[240:243], v[72:75], v[152:155]
    ds_read_b128 a[240:243], v206 offset:25472
    v_mfma_f32_16x16x32_bf16 v[120:123], a[244:247], v[12:15], v[120:123]
    v_exp_f32 v107, v107
    v_mfma_f32_16x16x32_bf16 v[128:131], a[244:247], v[28:31], v[128:131]
    v_exp_f32 v108, v108
    v_mfma_f32_16x16x32_bf16 v[136:139], a[244:247], v[44:47], v[136:139]
    v_exp_f32 v109, v109
    v_mfma_f32_16x16x32_bf16 v[144:147], a[244:247], v[60:63], v[144:147]
    v_cvt_pk_bf16_f32 v105, v106, v107
    v_cvt_pk_bf16_f32 v106, v108, v109
    v_mfma_f32_16x16x32_bf16 v[152:155], a[244:247], v[76:79], v[152:155]
    ds_read_b128 a[244:247], v206 offset:25536
    s_waitcnt lgkmcnt(2)
    v_mfma_f32_16x16x32_bf16 v[124:127], a[248:251], v[0:3], v[160:163]
    v_exp_f32 v110, v110
    v_mfma_f32_16x16x32_bf16 v[132:135], a[248:251], v[16:19], v[164:167]
    v_exp_f32 v111, v111
    v_mfma_f32_16x16x32_bf16 v[140:143], a[248:251], v[32:35], v[168:171]
    v_cvt_pk_bf16_f32 v107, v110, v111
    v_mfma_f32_16x16x32_bf16 v[148:151], a[248:251], v[48:51], v[172:175]
    v_exp_f32 v112, v112
    v_mfma_f32_16x16x32_bf16 v[156:159], a[248:251], v[64:67], v[176:179]
    v_exp_f32 v113, v113
    v_mfma_f32_16x16x32_bf16 v[124:127], a[252:255], v[4:7], v[124:127]
    v_exp_f32 v114, v114
    v_mfma_f32_16x16x32_bf16 v[132:135], a[252:255], v[20:23], v[132:135]
    v_cvt_pk_bf16_f32 v112, v112, v113
    v_max3_f32 v234, v120, v121, v122
    v_mfma_f32_16x16x32_bf16 v[140:143], a[252:255], v[36:39], v[140:143]
    v_exp_f32 v115, v115
    v_mfma_f32_16x16x32_bf16 v[148:151], a[252:255], v[52:55], v[148:151]
    v_exp_f32 v116, v116
    v_mfma_f32_16x16x32_bf16 v[156:159], a[252:255], v[68:71], v[156:159]
    v_cvt_pk_bf16_f32 v113, v114, v115
    s_waitcnt vmcnt(0) lgkmcnt(0)
    s_barrier
L_A_e14:
    v_mfma_f32_16x16x32_bf16 v[124:127], a[240:243], v[8:11], v[124:127]
    ds_read_b64_tr_b16 a[248:249], v207 offset:0
    ds_read_b64_tr_b16 a[250:251], v207 offset:256
    v_mfma_f32_16x16x32_bf16 v[132:135], a[240:243], v[24:27], v[132:135]
    ds_read_b64_tr_b16 a[252:253], v207 offset:32
    ds_read_b64_tr_b16 a[254:255], v207 offset:288
    s_cmp_eq_u32 s34, 0
    s_cbranch_scc0 L_s0a
    s_add_u32 s38, s38, 512
    s_mov_b32 s36, s35
    s_lshl_b32 s55, s36, 8
    s_add_u32 s55, s55, s54
    s_add_u32 s43, s37, 0
    s_lshl_b32 s46, s36, 20
    s_add_u32 s46, s46, s38
    s_add_u32 s48, s37, 67584
    s_add_u32 m0, s53, 118272
    s_add_u32 s39, s55, 0
    buffer_load_dwordx4 v210, s[20:23], s39 offen lds
    s_add_u32 m0, s53, 119328
    s_add_u32 s39, s55, 5120
    buffer_load_dwordx4 v210, s[20:23], s39 offen lds
    s_add_u32 m0, s53, 126720
    s_add_u32 s39, s55, 40960
    buffer_load_dwordx4 v210, s[20:23], s39 offen lds
    s_add_u32 m0, s53, 127776
    s_add_u32 s39, s55, 46080
    buffer_load_dwordx4 v210, s[20:23], s39 offen lds
L_s0b:
    v_mfma_f32_16x16x32_bf16 v[140:143], a[240:243], v[40:43], v[140:143]
    v_max3_f32 v235, v123, v128, v129
    v_max3_f32 v235, v235, v130, v131
    v_mfma_f32_16x16x32_bf16 v[148:151], a[240:243], v[56:59], v[148:151]
    v_exp_f32 v117, v117
    v_mfma_f32_16x16x32_bf16 v[156:159], a[240:243], v[72:75], v[156:159]
    ds_read_b64_tr_b16 a[240:241], v207 offset:64
    ds_read_b64_tr_b16 a[242:243], v207 offset:320
    v_mfma_f32_16x16x32_bf16 v[124:127], a[244:247], v[12:15], v[124:127]
    v_exp_f32 v118, v118
    v_mfma_f32_16x16x32_bf16 v[132:135], a[244:247], v[28:31], v[132:135]
    v_exp_f32 v119, v119
    v_mfma_f32_16x16x32_bf16 v[140:143], a[244:247], v[44:47], v[140:143]
    v_cvt_pk_bf16_f32 v114, v116, v117
    v_cvt_pk_bf16_f32 v115, v118, v119
    v_mfma_f32_16x16x32_bf16 v[148:151], a[244:247], v[60:63], v[148:151]
    v_max3_f32 v234, v234, v136, v137
    v_max3_f32 v235, v235, v138, v139
    v_mfma_f32_16x16x32_bf16 v[156:159], a[244:247], v[76:79], v[156:159]
    ds_read_b64_tr_b16 a[244:245], v207 offset:96
    s_waitcnt lgkmcnt(5)
    v_mfma_f32_16x16x32_bf16 a[0:3], a[248:251], v[80:83], a[0:3]
    ds_read_b64_tr_b16 a[246:247], v207 offset:352
    v_max3_f32 v234, v234, v144, v145
    v_mfma_f32_16x16x32_bf16 a[4:7], a[248:251], v[88:91], a[4:7]
    v_max3_f32 v235, v235, v146, v147
    v_max3_f32 v234, v234, v152, v153
    v_mfma_f32_16x16x32_bf16 a[8:11], a[248:251], v[96:99], a[8:11]
    v_max3_f32 v235, v235, v154, v155
    v_max3_f32 v234, v234, v124, v125
    v_mfma_f32_16x16x32_bf16 a[12:15], a[248:251], v[104:107], a[12:15]
    v_max3_f32 v235, v235, v126, v127
    v_max3_f32 v234, v234, v132, v133
    v_mfma_f32_16x16x32_bf16 a[16:19], a[248:251], v[112:115], a[16:19]
    ds_read_b64_tr_b16 a[248:249], v207 offset:128
    s_waitcnt lgkmcnt(5)
    v_mfma_f32_16x16x32_bf16 a[20:23], a[252:255], v[80:83], a[20:23]
    ds_read_b64_tr_b16 a[250:251], v207 offset:384
    v_max3_f32 v235, v235, v134, v135
    v_mfma_f32_16x16x32_bf16 a[24:27], a[252:255], v[88:91], a[24:27]
    v_max3_f32 v234, v234, v140, v141
    v_max3_f32 v235, v235, v142, v143
    v_mfma_f32_16x16x32_bf16 a[28:31], a[252:255], v[96:99], a[28:31]
    v_max3_f32 v234, v234, v148, v149
    v_max3_f32 v235, v235, v150, v151
    v_mfma_f32_16x16x32_bf16 a[32:35], a[252:255], v[104:107], a[32:35]
    v_max3_f32 v234, v234, v156, v157
    v_max3_f32 v235, v235, v158, v159
    v_mfma_f32_16x16x32_bf16 a[36:39], a[252:255], v[112:115], a[36:39]
    ds_read_b64_tr_b16 a[252:253], v207 offset:160
    ds_read_b64_tr_b16 a[254:255], v207 offset:416
    v_mfma_f32_16x16x32_bf16 v[180:183], v[200:203], v[80:83], v[180:183]
    v_max_f32 v234, v234, v235
    s_cmp_eq_u32 s34, 0
    s_cbranch_scc0 L_s1a
    s_add_u32 m0, s53, 135168
    s_add_u32 s39, s55, 81920
    buffer_load_dwordx4 v210, s[20:23], s39 offen lds
    s_add_u32 m0, s53, 136224
    s_add_u32 s39, s55, 87040
    buffer_load_dwordx4 v210, s[20:23], s39 offen lds
    s_add_u32 m0, s53, 143616
    s_add_u32 s39, s55, 122880
    buffer_load_dwordx4 v210, s[20:23], s39 offen lds
    s_add_u32 m0, s53, 144672
    s_add_u32 s39, s55, 128000
    buffer_load_dwordx4 v210, s[20:23], s39 offen lds
L_s1b:
    s_waitcnt lgkmcnt(4)
    v_mfma_f32_16x16x32_bf16 a[40:43], a[240:243], v[80:83], a[40:43]
    v_cmp_lt_f32 vcc, 0x41000000, v234
    s_cbranch_vccnz L_rre14
L_rbe14:
    v_mfma_f32_16x16x32_bf16 a[44:47], a[240:243], v[88:91], a[44:47]
    v_exp_f32 v120, v120
    v_mfma_f32_16x16x32_bf16 a[48:51], a[240:243], v[96:99], a[48:51]
    v_exp_f32 v121, v121
    v_mfma_f32_16x16x32_bf16 a[52:55], a[240:243], v[104:107], a[52:55]
    v_cvt_pk_bf16_f32 v120, v120, v121
    v_mfma_f32_16x16x32_bf16 a[56:59], a[240:243], v[112:115], a[56:59]
    ds_read_b64_tr_b16 a[240:241], v207 offset:192
    ds_read_b64_tr_b16 a[242:243], v207 offset:448
    v_mfma_f32_16x16x32_bf16 v[184:187], v[200:203], v[88:91], v[184:187]
    v_exp_f32 v122, v122
    v_mfma_f32_16x16x32_bf16 a[60:63], a[244:247], v[80:83], a[60:63]
    v_exp_f32 v123, v123
    v_mfma_f32_16x16x32_bf16 a[64:67], a[244:247], v[88:91], a[64:67]
    v_exp_f32 v124, v124
    v_mfma_f32_16x16x32_bf16 a[68:71], a[244:247], v[96:99], a[68:71]
    v_cvt_pk_bf16_f32 v121, v122, v123
    v_mfma_f32_16x16x32_bf16 a[72:75], a[244:247], v[104:107], a[72:75]
    v_exp_f32 v125, v125
    v_mfma_f32_16x16x32_bf16 a[76:79], a[244:247], v[112:115], a[76:79]
    ds_read_b64_tr_b16 a[244:245], v207 offset:224
    ds_read_b64_tr_b16 a[246:247], v207 offset:480
    v_mfma_f32_16x16x32_bf16 v[188:191], v[200:203], v[96:99], v[188:191]
    v_cvt_pk_bf16_f32 v122, v124, v125
    s_waitcnt lgkmcnt(4)
    v_mfma_f32_16x16x32_bf16 a[80:83], a[248:251], v[80:83], a[80:83]
    v_exp_f32 v126, v126
    v_mfma_f32_16x16x32_bf16 a[84:87], a[248:251], v[88:91], a[84:87]
    v_mfma_f32_16x16x32_bf16 a[88:91], a[248:251], v[96:99], a[88:91]
    v_exp_f32 v127, v127
    v_mfma_f32_16x16x32_bf16 a[92:95], a[248:251], v[104:107], a[92:95]
    v_exp_f32 v128, v128
    v_mfma_f32_16x16x32_bf16 a[96:99], a[248:251], v[112:115], a[96:99]
    v_cvt_pk_bf16_f32 v123, v126, v127
    v_mfma_f32_16x16x32_bf16 v[192:195], v[200:203], v[104:107], v[192:195]
    v_exp_f32 v129, v129
    v_mfma_f32_16x16x32_bf16 a[100:103], a[252:255], v[80:83], a[100:103]
    v_cvt_pk_bf16_f32 v128, v128, v129
    v_mfma_f32_16x16x32_bf16 a[104:107], a[252:255], v[88:91], a[104:107]
    v_exp_f32 v130, v130
    s_cmp_eq_u32 s34, 0
    s_cbranch_scc0 L_s2a
    s_add_u32 m0, s53, 152064
    s_add_u32 s39, s55, 163840
    buffer_load_dwordx4 v210, s[20:23], s39 offen lds
    s_add_u32 m0, s53, 153120
    s_add_u32 s39, s55, 168960
    buffer_load_dwordx4 v210, s[20:23], s39 offen lds
    s_add_u32 m0, s43, 0
    s_add_u32 s39, s46, 0
    buffer_load_dwordx4 v211, s[12:15], s39 offen lds
    s_add_u32 m0, s43, 1056
    s_add_u32 s39, s46, 65536
    buffer_load_dwordx4 v211, s[12:15], s39 offen lds
L_s2b:
    v_mfma_f32_16x16x32_bf16 a[108:111], a[252:255], v[96:99], a[108:111]
    v_exp_f32 v131, v131
    v_mfma_f32_16x16x32_bf16 a[112:115], a[252:255], v[104:107], a[112:115]
    v_cvt_pk_bf16_f32 v129, v130, v131
    v_mfma_f32_16x16x32_bf16 a[116:119], a[252:255], v[112:115], a[116:119]
    v_exp_f32 v132, v132
    v_mfma_f32_16x16x32_bf16 v[196:199], v[200:203], v[112:115], v[196:199]
    s_waitcnt lgkmcnt(0)
    v_mfma_f32_16x16x32_bf16 a[120:123], a[240:243], v[80:83], a[120:123]
    v_exp_f32 v133, v133
    v_mfma_f32_16x16x32_bf16 a[124:127], a[240:243], v[88:91], a[124:127]
    v_exp_f32 v134, v134
    v_mfma_f32_16x16x32_bf16 a[128:131], a[240:243], v[96:99], a[128:131]
    v_cvt_pk_bf16_f32 v130, v132, v133
    v_mfma_f32_16x16x32_bf16 a[132:135], a[240:243], v[104:107], a[132:135]
    v_exp_f32 v135, v135
    v_mfma_f32_16x16x32_bf16 a[136:139], a[240:243], v[112:115], a[136:139]
    v_cvt_pk_bf16_f32 v131, v134, v135
    v_mfma_f32_16x16x32_bf16 a[140:143], a[244:247], v[80:83], a[140:143]
    v_exp_f32 v136, v136
    v_mfma_f32_16x16x32_bf16 a[144:147], a[244:247], v[88:91], a[144:147]
    v_mfma_f32_16x16x32_bf16 a[148:151], a[244:247], v[96:99], a[148:151]
    v_exp_f32 v137, v137
    v_mfma_f32_16x16x32_bf16 a[152:155], a[244:247], v[104:107], a[152:155]
    v_exp_f32 v138, v138
    v_mfma_f32_16x16x32_bf16 a[156:159], a[244:247], v[112:115], a[156:159]
    v_exp_f32 v139, v139
    v_cvt_pk_bf16_f32 v136, v136, v137
    v_cvt_pk_bf16_f32 v137, v138, v139
    v_exp_f32 v140, v140
    v_exp_f32 v141, v141
    s_cbranch_vccnz L_p2e14
L_pbe14:
    v_cvt_pk_bf16_f32 v138, v140, v141
    v_exp_f32 v142, v142
    v_exp_f32 v143, v143
    v_exp_f32 v144, v144
    v_cvt_pk_bf16_f32 v139, v142, v143
    s_cmp_eq_u32 s34, 0
    s_cbranch_scc0 L_s3a
    s_add_u32 m0, s43, 2112
    s_add_u32 s39, s46, 8192
    buffer_load_dwordx4 v211, s[12:15], s39 offen lds
    s_add_u32 m0, s43, 3168
    s_add_u32 s39, s46, 73728
    buffer_load_dwordx4 v211, s[12:15], s39 offen lds
    s_add_u32 m0, s43, 4224
    s_add_u32 s39, s46, 16384
    buffer_load_dwordx4 v211, s[12:15], s39 offen lds
    s_add_u32 m0, s43, 5280
    s_add_u32 s39, s46, 81920
    buffer_load_dwordx4 v211, s[12:15], s39 offen lds
L_s3b:
    v_exp_f32 v145, v145
    v_exp_f32 v146, v146
    v_cvt_pk_bf16_f32 v144, v144, v145
    v_exp_f32 v147, v147
    v_exp_f32 v148, v148
    v_exp_f32 v149, v149
    v_cvt_pk_bf16_f32 v145, v146, v147
    v_cvt_pk_bf16_f32 v146, v148, v149
    v_exp_f32 v150, v150
    v_exp_f32 v151, v151
    s_nop 0
    v_cvt_pk_bf16_f32 v147, v150, v151
    v_exp_f32 v152, v152
    v_exp_f32 v153, v153
    v_exp_f32 v154, v154
    v_cvt_pk_bf16_f32 v152, v152, v153
    v_exp_f32 v155, v155
    v_exp_f32 v156, v156
    v_cvt_pk_bf16_f32 v153, v154, v155
L_A_e15:
    ds_read_b64_tr_b16 a[248:249], v207 offset:8448
    ds_read_b64_tr_b16 a[250:251], v207 offset:8704
    ds_read_b64_tr_b16 a[252:253], v207 offset:8480
    ds_read_b64_tr_b16 a[254:255], v207 offset:8736
    v_exp_f32 v157, v157
    ds_read_b64_tr_b16 a[240:241], v207 offset:8512
    ds_read_b64_tr_b16 a[242:243], v207 offset:8768
    v_exp_f32 v158, v158
    v_exp_f32 v159, v159
    v_cvt_pk_bf16_f32 v154, v156, v157
    v_cvt_pk_bf16_f32 v155, v158, v159
    ds_read_b64_tr_b16 a[244:245], v207 offset:8544
    s_waitcnt lgkmcnt(5)
    v_mfma_f32_16x16x32_bf16 a[0:3], a[248:251], v[120:123], a[0:3]
    ds_read_b64_tr_b16 a[246:247], v207 offset:8800
    v_mfma_f32_16x16x32_bf16 a[4:7], a[248:251], v[128:131], a[4:7]
    v_mfma_f32_16x16x32_bf16 a[8:11], a[248:251], v[136:139], a[8:11]
    s_cmp_eq_u32 s34, 0
    s_cbranch_scc0 L_s4a
    s_add_u32 m0, s43, 6336
    s_add_u32 s39, s46, 24576
    buffer_load_dwordx4 v211, s[12:15], s39 offen lds
    s_add_u32 m0, s43, 7392
    s_add_u32 s39, s46, 90112
    buffer_load_dwordx4 v211, s[12:15], s39 offen lds
    s_add_u32 m0, s48, 0
    s_add_u32 s39, s46, 524288
    buffer_load_dwordx4 v211, s[12:15], s39 offen lds
    s_add_u32 m0, s48, 1056
    s_add_u32 s39, s46, 589824
    buffer_load_dwordx4 v211, s[12:15], s39 offen lds
L_s4b:
    v_mfma_f32_16x16x32_bf16 a[12:15], a[248:251], v[144:147], a[12:15]
    v_mfma_f32_16x16x32_bf16 a[16:19], a[248:251], v[152:155], a[16:19]
    ds_read_b64_tr_b16 a[248:249], v207 offset:8576
    s_waitcnt lgkmcnt(5)
    v_mfma_f32_16x16x32_bf16 a[20:23], a[252:255], v[120:123], a[20:23]
    ds_read_b64_tr_b16 a[250:251], v207 offset:8832
    v_mfma_f32_16x16x32_bf16 a[24:27], a[252:255], v[128:131], a[24:27]
    v_mfma_f32_16x16x32_bf16 a[28:31], a[252:255], v[136:139], a[28:31]
    v_mfma_f32_16x16x32_bf16 a[32:35], a[252:255], v[144:147], a[32:35]
    v_mfma_f32_16x16x32_bf16 a[36:39], a[252:255], v[152:155], a[36:39]
    ds_read_b64_tr_b16 a[252:253], v207 offset:8608
    ds_read_b64_tr_b16 a[254:255], v207 offset:8864
    v_mfma_f32_16x16x32_bf16 v[180:183], v[200:203], v[120:123], v[180:183]
    s_waitcnt lgkmcnt(4)
    v_mfma_f32_16x16x32_bf16 a[40:43], a[240:243], v[120:123], a[40:43]
    v_mfma_f32_16x16x32_bf16 a[44:47], a[240:243], v[128:131], a[44:47]
    v_mfma_f32_16x16x32_bf16 a[48:51], a[240:243], v[136:139], a[48:51]
    v_accvgpr_read_b32 v80, a0
    v_accvgpr_read_b32 v81, a1
    v_mfma_f32_16x16x32_bf16 a[52:55], a[240:243], v[144:147], a[52:55]
    v_accvgpr_read_b32 v82, a2
    v_accvgpr_read_b32 v83, a3
    v_mfma_f32_16x16x32_bf16 a[56:59], a[240:243], v[152:155], a[56:59]
    ds_read_b64_tr_b16 a[240:241], v207 offset:8640
    ds_read_b64_tr_b16 a[242:243], v207 offset:8896
    v_accvgpr_read_b32 v84, a20
    v_accvgpr_read_b32 v85, a21
    v_mfma_f32_16x16x32_bf16 v[184:187], v[200:203], v[128:131], v[184:187]
    v_accvgpr_read_b32 v86, a22
    v_accvgpr_read_b32 v87, a23
    v_mfma_f32_16x16x32_bf16 a[60:63], a[244:247], v[120:123], a[60:63]
    v_accvgpr_read_b32 v88, a4
    v_accvgpr_read_b32 v89, a5
    v_mfma_f32_16x16x32_bf16 a[64:67], a[244:247], v[128:131], a[64:67]
    v_accvgpr_read_b32 v90, a6
    v_accvgpr_read_b32 v91, a7
    v_mfma_f32_16x16x32_bf16 a[68:71], a[244:247], v[136:139], a[68:71]
    v_accvgpr_read_b32 v92, a24
    v_accvgpr_read_b32 v93, a25
    v_mfma_f32_16x16x32_bf16 a[72:75], a[244:247], v[144:147], a[72:75]
    v_accvgpr_read_b32 v94, a26
    v_accvgpr_read_b32 v95, a27
    v_mfma_f32_16x16x32_bf16 a[76:79], a[244:247], v[152:155], a[76:79]
    ds_read_b64_tr_b16 a[244:245], v207 offset:8672
    ds_read_b64_tr_b16 a[246:247], v207 offset:8928
    v_accvgpr_read_b32 v96, a8
    v_accvgpr_read_b32 v97, a9
    v_mfma_f32_16x16x32_bf16 v[188:191], v[200:203], v[136:139], v[188:191]
    v_accvgpr_read_b32 v98, a10
    v_accvgpr_read_b32 v99, a11
    s_waitcnt lgkmcnt(4)
    v_mfma_f32_16x16x32_bf16 a[80:83], a[248:251], v[120:123], a[80:83]
    v_accvgpr_read_b32 v100, a28
    v_accvgpr_read_b32 v101, a29
    v_mfma_f32_16x16x32_bf16 a[84:87], a[248:251], v[128:131], a[84:87]
    v_accvgpr_read_b32 v102, a30
    v_accvgpr_read_b32 v103, a31
    v_mfma_f32_16x16x32_bf16 a[88:91], a[248:251], v[136:139], a[88:91]
    s_cmp_eq_u32 s34, 0
    s_cbranch_scc0 L_s5a
    s_add_u32 m0, s48, 2112
    s_add_u32 s39, s46, 532480
    buffer_load_dwordx4 v211, s[12:15], s39 offen lds
    s_add_u32 m0, s48, 3168
    s_add_u32 s39, s46, 598016
    buffer_load_dwordx4 v211, s[12:15], s39 offen lds
    s_add_u32 m0, s48, 4224
    s_add_u32 s39, s46, 540672
    buffer_load_dwordx4 v211, s[12:15], s39 offen lds
    s_add_u32 m0, s48, 5280
    s_add_u32 s39, s46, 606208
    buffer_load_dwordx4 v211, s[12:15], s39 offen lds
L_s5b:
    v_accvgpr_read_b32 v104, a12
    v_accvgpr_read_b32 v105, a13
    v_mfma_f32_16x16x32_bf16 a[92:95], a[248:251], v[144:147], a[92:95]
    v_accvgpr_read_b32 v106, a14
    v_accvgpr_read_b32 v107, a15
    v_mfma_f32_16x16x32_bf16 a[96:99], a[248:251], v[152:155], a[96:99]
    v_accvgpr_read_b32 v108, a32
    v_accvgpr_read_b32 v109, a33
    v_mfma_f32_16x16x32_bf16 v[192:195], v[200:203], v[144:147], v[192:195]
    v_accvgpr_read_b32 v110, a34
    v_accvgpr_read_b32 v111, a35
    v_mfma_f32_16x16x32_bf16 a[100:103], a[252:255], v[120:123], a[100:103]
    v_accvgpr_read_b32 v112, a16
    v_accvgpr_read_b32 v113, a17
    v_mfma_f32_16x16x32_bf16 a[104:107], a[252:255], v[128:131], a[104:107]
    v_accvgpr_read_b32 v114, a18
    v_accvgpr_read_b32 v115, a19
    v_mfma_f32_16x16x32_bf16 a[108:111], a[252:255], v[136:139], a[108:111]
    v_accvgpr_read_b32 v116, a36
    v_accvgpr_read_b32 v117, a37
    v_mfma_f32_16x16x32_bf16 a[112:115], a[252:255], v[144:147], a[112:115]
    v_accvgpr_read_b32 v118, a38
    v_accvgpr_read_b32 v119, a39
    v_mfma_f32_16x16x32_bf16 a[116:119], a[252:255], v[152:155], a[116:119]
    v_accvgpr_read_b32 v8, a40
    v_accvgpr_read_b32 v9, a41
    v_accvgpr_read_b32 v10, a42
    v_mfma_f32_16x16x32_bf16 v[196:199], v[200:203], v[152:155], v[196:199]
    v_accvgpr_read_b32 v11, a43
    v_accvgpr_read_b32 v12, a60
    v_accvgpr_read_b32 v13, a61
    v_accvgpr_read_b32 v14, a62
    s_waitcnt lgkmcnt(0)
    v_mfma_f32_16x16x32_bf16 a[120:123], a[240:243], v[120:123], a[120:123]
    v_accvgpr_read_b32 v15, a63
    v_accvgpr_read_b32 v24, a44
    v_accvgpr_read_b32 v25, a45
    v_mfma_f32_16x16x32_bf16 a[124:127], a[240:243], v[128:131], a[124:127]
    v_accvgpr_read_b32 v26, a46
    v_accvgpr_read_b32 v27, a47
    v_accvgpr_read_b32 v28, a64
    v_mfma_f32_16x16x32_bf16 a[128:131], a[240:243], v[136:139], a[128:131]
    v_accvgpr_read_b32 v29, a65
    v_accvgpr_read_b32 v30, a66
    v_accvgpr_read_b32 v31, a67
    v_accvgpr_read_b32 v40, a48
    v_mfma_f32_16x16x32_bf16 a[132:135], a[240:243], v[144:147], a[132:135]
    v_accvgpr_read_b32 v41, a49
    v_accvgpr_read_b32 v42, a50
    v_accvgpr_read_b32 v43, a51
    v_mfma_f32_16x16x32_bf16 a[136:139], a[240:243], v[152:155], a[136:139]
    v_accvgpr_read_b32 v44, a68
    v_accvgpr_read_b32 v45, a69
    v_accvgpr_read_b32 v46, a70
    v_mfma_f32_16x16x32_bf16 a[140:143], a[244:247], v[120:123], a[140:143]
    v_accvgpr_read_b32 v47, a71
    v_accvgpr_read_b32 v56, a52
    v_accvgpr_read_b32 v57, a53
    v_accvgpr_read_b32 v58, a54
    v_mfma_f32_16x16x32_bf16 a[144:147], a[244:247], v[128:131], a[144:147]
    v_accvgpr_read_b32 v59, a55
    v_accvgpr_read_b32 v60, a72
    v_accvgpr_read_b32 v61, a73
    v_mfma_f32_16x16x32_bf16 a[148:151], a[244:247], v[136:139], a[148:151]
    v_accvgpr_read_b32 v62, a74
    v_accvgpr_read_b32 v63, a75
    v_accvgpr_read_b32 v72, a56
    v_mfma_f32_16x16x32_bf16 a[152:155], a[244:247], v[144:147], a[152:155]
    v_accvgpr_read_b32 v73, a57
    v_accvgpr_read_b32 v74, a58
    v_accvgpr_read_b32 v75, a59
    v_accvgpr_read_b32 v76, a76
    v_mfma_f32_16x16x32_bf16 a[156:159], a[244:247], v[152:155], a[156:159]
    v_accvgpr_read_b32 v77, a77
    v_accvgpr_read_b32 v78, a78
    v_accvgpr_read_b32 v79, a79
    v_rcp_f32 v218, v180
    v_rcp_f32 v220, v184
    v_rcp_f32 v246, v188
    v_rcp_f32 v248, v192
    v_rcp_f32 v250, v196
    s_cmp_eq_u32 s34, 0
    s_cbranch_scc0 L_s6a
    s_add_u32 m0, s48, 6336
    s_add_u32 s39, s46, 548864
    buffer_load_dwordx4 v211, s[12:15], s39 offen lds
    s_add_u32 m0, s48, 7392
    s_add_u32 s39, s46, 614400
    buffer_load_dwordx4 v211, s[12:15], s39 offen lds
L_s6b:
    v_pk_mul_f32 v[80:81], v[80:81], v[218:219] op_sel_hi:[1,0]
    v_pk_mul_f32 v[82:83], v[82:83], v[218:219] op_sel_hi:[1,0]
    v_pk_mul_f32 v[84:85], v[84:85], v[218:219] op_sel_hi:[1,0]
    v_pk_mul_f32 v[86:87], v[86:87], v[218:219] op_sel_hi:[1,0]
    v_cvt_pk_bf16_f32 v0, v80, v81
    v_cvt_pk_bf16_f32 v1, v82, v83
    v_cvt_pk_bf16_f32 v2, v84, v85
    v_cvt_pk_bf16_f32 v3, v86, v87
    v_pk_mul_f32 v[88:89], v[88:89], v[220:221] op_sel_hi:[1,0]
    v_pk_mul_f32 v[90:91], v[90:91], v[220:221] op_sel_hi:[1,0]
    v_pk_mul_f32 v[92:93], v[92:93], v[220:221] op_sel_hi:[1,0]
    v_pk_mul_f32 v[94:95], v[94:95], v[220:221] op_sel_hi:[1,0]
    v_cvt_pk_bf16_f32 v16, v88, v89
    v_cvt_pk_bf16_f32 v17, v90, v91
    v_cvt_pk_bf16_f32 v18, v92, v93
    v_cvt_pk_bf16_f32 v19, v94, v95
    v_pk_mul_f32 v[96:97], v[96:97], v[246:247] op_sel_hi:[1,0]
    v_pk_mul_f32 v[98:99], v[98:99], v[246:247] op_sel_hi:[1,0]
    v_pk_mul_f32 v[100:101], v[100:101], v[246:247] op_sel_hi:[1,0]
    v_pk_mul_f32 v[102:103], v[102:103], v[246:247] op_sel_hi:[1,0]
    v_cvt_pk_bf16_f32 v32, v96, v97
    v_cvt_pk_bf16_f32 v33, v98, v99
    v_cvt_pk_bf16_f32 v34, v100, v101
    v_cvt_pk_bf16_f32 v35, v102, v103
    v_pk_mul_f32 v[104:105], v[104:105], v[248:249] op_sel_hi:[1,0]
    v_pk_mul_f32 v[106:107], v[106:107], v[248:249] op_sel_hi:[1,0]
    v_pk_mul_f32 v[108:109], v[108:109], v[248:249] op_sel_hi:[1,0]
    v_pk_mul_f32 v[110:111], v[110:111], v[248:249] op_sel_hi:[1,0]
    v_cvt_pk_bf16_f32 v48, v104, v105
    v_cvt_pk_bf16_f32 v49, v106, v107
    v_cvt_pk_bf16_f32 v50, v108, v109
    v_cvt_pk_bf16_f32 v51, v110, v111
    v_pk_mul_f32 v[112:113], v[112:113], v[250:251] op_sel_hi:[1,0]
    v_pk_mul_f32 v[114:115], v[114:115], v[250:251] op_sel_hi:[1,0]
    v_pk_mul_f32 v[116:117], v[116:117], v[250:251] op_sel_hi:[1,0]
    v_pk_mul_f32 v[118:119], v[118:119], v[250:251] op_sel_hi:[1,0]
    v_cvt_pk_bf16_f32 v64, v112, v113
    v_cvt_pk_bf16_f32 v65, v114, v115
    v_cvt_pk_bf16_f32 v66, v116, v117
    v_cvt_pk_bf16_f32 v67, v118, v119
    s_cmp_eq_u32 s34, 0
    s_cbranch_scc0 L_s7a
L_s7b:
    v_pk_mul_f32 v[8:9], v[8:9], v[218:219] op_sel_hi:[1,0]
    v_pk_mul_f32 v[10:11], v[10:11], v[218:219] op_sel_hi:[1,0]
    v_pk_mul_f32 v[12:13], v[12:13], v[218:219] op_sel_hi:[1,0]
    v_pk_mul_f32 v[14:15], v[14:15], v[218:219] op_sel_hi:[1,0]
    v_cvt_pk_bf16_f32 v4, v8, v9
    v_cvt_pk_bf16_f32 v5, v10, v11
    v_cvt_pk_bf16_f32 v6, v12, v13
    v_cvt_pk_bf16_f32 v7, v14, v15
    v_pk_mul_f32 v[24:25], v[24:25], v[220:221] op_sel_hi:[1,0]
    v_pk_mul_f32 v[26:27], v[26:27], v[220:221] op_sel_hi:[1,0]
    v_pk_mul_f32 v[28:29], v[28:29], v[220:221] op_sel_hi:[1,0]
    v_pk_mul_f32 v[30:31], v[30:31], v[220:221] op_sel_hi:[1,0]
    v_cvt_pk_bf16_f32 v20, v24, v25
    v_cvt_pk_bf16_f32 v21, v26, v27
    v_cvt_pk_bf16_f32 v22, v28, v29
    v_cvt_pk_bf16_f32 v23, v30, v31
    v_pk_mul_f32 v[40:41], v[40:41], v[246:247] op_sel_hi:[1,0]
    v_pk_mul_f32 v[42:43], v[42:43], v[246:247] op_sel_hi:[1,0]
    v_pk_mul_f32 v[44:45], v[44:45], v[246:247] op_sel_hi:[1,0]
    v_pk_mul_f32 v[46:47], v[46:47], v[246:247] op_sel_hi:[1,0]
    v_cvt_pk_bf16_f32 v36, v40, v41
    v_cvt_pk_bf16_f32 v37, v42, v43
    v_cvt_pk_bf16_f32 v38, v44, v45
    v_cvt_pk_bf16_f32 v39, v46, v47
    v_pk_mul_f32 v[56:57], v[56:57], v[248:249] op_sel_hi:[1,0]
    v_pk_mul_f32 v[58:59], v[58:59], v[248:249] op_sel_hi:[1,0]
    v_pk_mul_f32 v[60:61], v[60:61], v[248:249] op_sel_hi:[1,0]
    v_pk_mul_f32 v[62:63], v[62:63], v[248:249] op_sel_hi:[1,0]
    v_cvt_pk_bf16_f32 v52, v56, v57
    v_cvt_pk_bf16_f32 v53, v58, v59
    v_cvt_pk_bf16_f32 v54, v60, v61
    v_cvt_pk_bf16_f32 v55, v62, v63
    v_pk_mul_f32 v[72:73], v[72:73], v[250:251] op_sel_hi:[1,0]
    v_pk_mul_f32 v[74:75], v[74:75], v[250:251] op_sel_hi:[1,0]
    v_pk_mul_f32 v[76:77], v[76:77], v[250:251] op_sel_hi:[1,0]
    v_pk_mul_f32 v[78:79], v[78:79], v[250:251] op_sel_hi:[1,0]
    v_cvt_pk_bf16_f32 v68, v72, v73
    v_cvt_pk_bf16_f32 v69, v74, v75
    v_cvt_pk_bf16_f32 v70, v76, v77
    v_cvt_pk_bf16_f32 v71, v78, v79
    s_cmp_eq_u32 s34, 0
    s_cbranch_scc0 L_s8a
L_s8b:
    v_accvgpr_read_b32 v120, a80
    v_accvgpr_read_b32 v121, a81
    v_accvgpr_read_b32 v122, a82
    v_accvgpr_read_b32 v123, a83
    v_accvgpr_read_b32 v124, a100
    v_accvgpr_read_b32 v125, a101
    v_accvgpr_read_b32 v126, a102
    v_accvgpr_read_b32 v127, a103
    v_pk_mul_f32 v[120:121], v[120:121], v[218:219] op_sel_hi:[1,0]
    v_pk_mul_f32 v[122:123], v[122:123], v[218:219] op_sel_hi:[1,0]
    v_pk_mul_f32 v[124:125], v[124:125], v[218:219] op_sel_hi:[1,0]
    v_pk_mul_f32 v[126:127], v[126:127], v[218:219] op_sel_hi:[1,0]
    v_cvt_pk_bf16_f32 v8, v120, v121
    v_cvt_pk_bf16_f32 v9, v122, v123
    v_cvt_pk_bf16_f32 v10, v124, v125
    v_cvt_pk_bf16_f32 v11, v126, v127
    v_accvgpr_read_b32 v128, a84
    v_accvgpr_read_b32 v129, a85
    v_accvgpr_read_b32 v130, a86
    v_accvgpr_read_b32 v131, a87
    v_accvgpr_read_b32 v132, a104
    v_accvgpr_read_b32 v133, a105
    v_accvgpr_read_b32 v134, a106
    v_accvgpr_read_b32 v135, a107
    v_pk_mul_f32 v[128:129], v[128:129], v[220:221] op_sel_hi:[1,0]
    v_pk_mul_f32 v[130:131], v[130:131], v[220:221] op_sel_hi:[1,0]
    v_pk_mul_f32 v[132:133], v[132:133], v[220:221] op_sel_hi:[1,0]
    v_pk_mul_f32 v[134:135], v[134:135], v[220:221] op_sel_hi:[1,0]
    v_cvt_pk_bf16_f32 v24, v128, v129
    v_cvt_pk_bf16_f32 v25, v130, v131
    v_cvt_pk_bf16_f32 v26, v132, v133
    v_cvt_pk_bf16_f32 v27, v134, v135
    v_accvgpr_read_b32 v136, a88
    v_accvgpr_read_b32 v137, a89
    v_accvgpr_read_b32 v138, a90
    v_accvgpr_read_b32 v139, a91
    v_accvgpr_read_b32 v140, a108
    v_accvgpr_read_b32 v141, a109
    v_accvgpr_read_b32 v142, a110
    v_accvgpr_read_b32 v143, a111
    v_pk_mul_f32 v[136:137], v[136:137], v[246:247] op_sel_hi:[1,0]
    v_pk_mul_f32 v[138:139], v[138:139], v[246:247] op_sel_hi:[1,0]
    v_pk_mul_f32 v[140:141], v[140:141], v[246:247] op_sel_hi:[1,0]
    v_pk_mul_f32 v[142:143], v[142:143], v[246:247] op_sel_hi:[1,0]
    v_cvt_pk_bf16_f32 v40, v136, v137
    v_cvt_pk_bf16_f32 v41, v138, v139
    v_cvt_pk_bf16_f32 v42, v140, v141
    v_cvt_pk_bf16_f32 v43, v142, v143
    v_accvgpr_read_b32 v144, a92
    v_accvgpr_read_b32 v145, a93
    v_accvgpr_read_b32 v146, a94
    v_accvgpr_read_b32 v147, a95
    v_accvgpr_read_b32 v148, a112
    v_accvgpr_read_b32 v149, a113
    v_accvgpr_read_b32 v150, a114
    v_accvgpr_read_b32 v151, a115
    v_pk_mul_f32 v[144:145], v[144:145], v[248:249] op_sel_hi:[1,0]
    v_pk_mul_f32 v[146:147], v[146:147], v[248:249] op_sel_hi:[1,0]
    v_pk_mul_f32 v[148:149], v[148:149], v[248:249] op_sel_hi:[1,0]
    v_pk_mul_f32 v[150:151], v[150:151], v[248:249] op_sel_hi:[1,0]
    v_cvt_pk_bf16_f32 v56, v144, v145
    v_cvt_pk_bf16_f32 v57, v146, v147
    v_cvt_pk_bf16_f32 v58, v148, v149
    v_cvt_pk_bf16_f32 v59, v150, v151
    v_accvgpr_read_b32 v152, a96
    v_accvgpr_read_b32 v153, a97
    v_accvgpr_read_b32 v154, a98
    v_accvgpr_read_b32 v155, a99
    v_accvgpr_read_b32 v156, a116
    v_accvgpr_read_b32 v157, a117
    v_accvgpr_read_b32 v158, a118
    v_accvgpr_read_b32 v159, a119
    v_pk_mul_f32 v[152:153], v[152:153], v[250:251] op_sel_hi:[1,0]
    v_pk_mul_f32 v[154:155], v[154:155], v[250:251] op_sel_hi:[1,0]
    v_pk_mul_f32 v[156:157], v[156:157], v[250:251] op_sel_hi:[1,0]
    v_pk_mul_f32 v[158:159], v[158:159], v[250:251] op_sel_hi:[1,0]
    v_cvt_pk_bf16_f32 v72, v152, v153
    v_cvt_pk_bf16_f32 v73, v154, v155
    v_cvt_pk_bf16_f32 v74, v156, v157
    v_cvt_pk_bf16_f32 v75, v158, v159
    v_accvgpr_read_b32 v80, a120
    v_accvgpr_read_b32 v81, a121
    v_accvgpr_read_b32 v82, a122
    v_accvgpr_read_b32 v83, a123
    v_accvgpr_read_b32 v84, a140
    v_accvgpr_read_b32 v85, a141
    v_accvgpr_read_b32 v86, a142
    v_accvgpr_read_b32 v87, a143
    v_pk_mul_f32 v[80:81], v[80:81], v[218:219] op_sel_hi:[1,0]
    v_pk_mul_f32 v[82:83], v[82:83], v[218:219] op_sel_hi:[1,0]
    v_pk_mul_f32 v[84:85], v[84:85], v[218:219] op_sel_hi:[1,0]
    v_pk_mul_f32 v[86:87], v[86:87], v[218:219] op_sel_hi:[1,0]
    v_cvt_pk_bf16_f32 v12, v80, v81
    v_cvt_pk_bf16_f32 v13, v82, v83
    v_cvt_pk_bf16_f32 v14, v84, v85
    v_cvt_pk_bf16_f32 v15, v86, v87
    v_accvgpr_read_b32 v88, a124
    v_accvgpr_read_b32 v89, a125
    v_accvgpr_read_b32 v90, a126
    v_accvgpr_read_b32 v91, a127
    v_accvgpr_read_b32 v92, a144
    v_accvgpr_read_b32 v93, a145
    v_accvgpr_read_b32 v94, a146
    v_accvgpr_read_b32 v95, a147
    v_pk_mul_f32 v[88:89], v[88:89], v[220:221] op_sel_hi:[1,0]
    v_pk_mul_f32 v[90:91], v[90:91], v[220:221] op_sel_hi:[1,0]
    v_pk_mul_f32 v[92:93], v[92:93], v[220:221] op_sel_hi:[1,0]
    v_pk_mul_f32 v[94:95], v[94:95], v[220:221] op_sel_hi:[1,0]
    v_cvt_pk_bf16_f32 v28, v88, v89
    v_cvt_pk_bf16_f32 v29, v90, v91
    v_cvt_pk_bf16_f32 v30, v92, v93
    v_cvt_pk_bf16_f32 v31, v94, v95
    v_accvgpr_read_b32 v96, a128
    v_accvgpr_read_b32 v97, a129
    v_accvgpr_read_b32 v98, a130
    v_accvgpr_read_b32 v99, a131
    v_accvgpr_read_b32 v100, a148
    v_accvgpr_read_b32 v101, a149
    v_accvgpr_read_b32 v102, a150
    v_accvgpr_read_b32 v103, a151
    v_pk_mul_f32 v[96:97], v[96:97], v[246:247] op_sel_hi:[1,0]
    v_pk_mul_f32 v[98:99], v[98:99], v[246:247] op_sel_hi:[1,0]
    v_pk_mul_f32 v[100:101], v[100:101], v[246:247] op_sel_hi:[1,0]
    v_pk_mul_f32 v[102:103], v[102:103], v[246:247] op_sel_hi:[1,0]
    v_cvt_pk_bf16_f32 v44, v96, v97
    v_cvt_pk_bf16_f32 v45, v98, v99
    v_cvt_pk_bf16_f32 v46, v100, v101
    v_cvt_pk_bf16_f32 v47, v102, v103
    v_accvgpr_read_b32 v104, a132
    v_accvgpr_read_b32 v105, a133
    v_accvgpr_read_b32 v106, a134
    v_accvgpr_read_b32 v107, a135
    v_accvgpr_read_b32 v108, a152
    v_accvgpr_read_b32 v109, a153
    v_accvgpr_read_b32 v110, a154
    v_accvgpr_read_b32 v111, a155
    v_pk_mul_f32 v[104:105], v[104:105], v[248:249] op_sel_hi:[1,0]
    v_pk_mul_f32 v[106:107], v[106:107], v[248:249] op_sel_hi:[1,0]
    v_pk_mul_f32 v[108:109], v[108:109], v[248:249] op_sel_hi:[1,0]
    v_pk_mul_f32 v[110:111], v[110:111], v[248:249] op_sel_hi:[1,0]
    v_cvt_pk_bf16_f32 v60, v104, v105
    v_cvt_pk_bf16_f32 v61, v106, v107
    v_cvt_pk_bf16_f32 v62, v108, v109
    v_cvt_pk_bf16_f32 v63, v110, v111
    v_accvgpr_read_b32 v112, a136
    v_accvgpr_read_b32 v113, a137
    v_accvgpr_read_b32 v114, a138
    v_accvgpr_read_b32 v115, a139
    v_accvgpr_read_b32 v116, a156
    v_accvgpr_read_b32 v117, a157
    v_accvgpr_read_b32 v118, a158
    v_accvgpr_read_b32 v119, a159
    v_pk_mul_f32 v[112:113], v[112:113], v[250:251] op_sel_hi:[1,0]
    v_pk_mul_f32 v[114:115], v[114:115], v[250:251] op_sel_hi:[1,0]
    v_pk_mul_f32 v[116:117], v[116:117], v[250:251] op_sel_hi:[1,0]
    v_pk_mul_f32 v[118:119], v[118:119], v[250:251] op_sel_hi:[1,0]
    v_cvt_pk_bf16_f32 v76, v112, v113
    v_cvt_pk_bf16_f32 v77, v114, v115
    v_cvt_pk_bf16_f32 v78, v116, v117
    v_cvt_pk_bf16_f32 v79, v118, v119
    s_cmp_eq_u32 s34, 1
    s_cbranch_scc1 L_T
    s_mov_b32 s34, 1
    s_waitcnt vmcnt(0)
    s_barrier
    s_add_u32 s4, s4, 262144
    s_addc_u32 s5, s5, 0
    s_add_u32 s8, s8, 262144
    s_addc_u32 s9, s9, 0
    ds_read_b128 a[0:3], v212 offset:0
    v_accvgpr_write_b32 a160, v0
    v_accvgpr_write_b32 a161, v1
    v_accvgpr_write_b32 a162, v2
    v_accvgpr_write_b32 a163, v3
    ds_read_b128 a[16:19], v213 offset:0
    v_accvgpr_write_b32 a164, v4
    v_accvgpr_write_b32 a165, v5
    v_accvgpr_write_b32 a166, v6
    v_accvgpr_write_b32 a167, v7
    ds_read_b128 a[32:35], v212 offset:8448
    v_accvgpr_write_b32 a168, v8
    v_accvgpr_write_b32 a169, v9
    v_accvgpr_write_b32 a170, v10
    v_accvgpr_write_b32 a171, v11
    ds_read_b128 a[48:51], v213 offset:8448
    v_accvgpr_write_b32 a172, v12
    v_accvgpr_write_b32 a173, v13
    v_accvgpr_write_b32 a174, v14
    v_accvgpr_write_b32 a175, v15
    ds_read_b128 a[64:67], v212 offset:16896
    v_accvgpr_write_b32 a176, v16
    v_accvgpr_write_b32 a177, v17
    v_accvgpr_write_b32 a178, v18
    v_accvgpr_write_b32 a179, v19
    ds_read_b128 a[4:7], v212 offset:64
    v_accvgpr_write_b32 a180, v20
    v_accvgpr_write_b32 a181, v21
    v_accvgpr_write_b32 a182, v22
    v_accvgpr_write_b32 a183, v23
    ds_read_b128 a[20:23], v213 offset:64
    v_accvgpr_write_b32 a184, v24
    v_accvgpr_write_b32 a185, v25
    v_accvgpr_write_b32 a186, v26
    v_accvgpr_write_b32 a187, v27
    ds_read_b128 a[36:39], v212 offset:8512
    v_accvgpr_write_b32 a188, v28
    v_accvgpr_write_b32 a189, v29
    v_accvgpr_write_b32 a190, v30
    v_accvgpr_write_b32 a191, v31
    ds_read_b128 a[52:55], v213 offset:8512
    v_accvgpr_write_b32 a192, v32
    v_accvgpr_write_b32 a193, v33
    v_accvgpr_write_b32 a194, v34
    v_accvgpr_write_b32 a195, v35
    ds_read_b128 a[68:71], v212 offset:16960
    v_accvgpr_write_b32 a196, v36
    v_accvgpr_write_b32 a197, v37
    v_accvgpr_write_b32 a198, v38
    v_accvgpr_write_b32 a199, v39
    ds_read_b128 a[80:83], v212 offset:128
    v_accvgpr_write_b32 a200, v40
    v_accvgpr_write_b32 a201, v41
    v_accvgpr_write_b32 a202, v42
    v_accvgpr_write_b32 a203, v43
    ds_read_b128 a[88:91], v213 offset:128
    v_accvgpr_write_b32 a204, v44
    v_accvgpr_write_b32 a205, v45
    v_accvgpr_write_b32 a206, v46
    v_accvgpr_write_b32 a207, v47
    s_waitcnt lgkmcnt(4)
    ds_read_b128 a[96:99], v212 offset:8576
    v_accvgpr_write_b32 a208, v48
    v_accvgpr_write_b32 a209, v49
    v_accvgpr_write_b32 a210, v50
    v_accvgpr_write_b32 a211, v51
    ds_read_b128 a[104:107], v213 offset:8576
    v_accvgpr_write_b32 a212, v52
    v_accvgpr_write_b32 a213, v53
    v_accvgpr_write_b32 a214, v54
    v_accvgpr_write_b32 a215, v55
    ds_read_b128 a[112:115], v212 offset:17024
    v_accvgpr_write_b32 a216, v56
    v_accvgpr_write_b32 a217, v57
    v_accvgpr_write_b32 a218, v58
    v_accvgpr_write_b32 a219, v59
    ds_read_b128 a[84:87], v212 offset:192
    v_accvgpr_write_b32 a220, v60
    v_accvgpr_write_b32 a221, v61
    v_accvgpr_write_b32 a222, v62
    v_accvgpr_write_b32 a223, v63
    ds_read_b128 a[92:95], v213 offset:192
    v_accvgpr_write_b32 a224, v64
    v_accvgpr_write_b32 a225, v65
    v_accvgpr_write_b32 a226, v66
    v_accvgpr_write_b32 a227, v67
    ds_read_b128 a[100:103], v212 offset:8640
    v_accvgpr_write_b32 a228, v68
    v_accvgpr_write_b32 a229, v69
    v_accvgpr_write_b32 a230, v70
    v_accvgpr_write_b32 a231, v71
    ds_read_b128 a[108:111], v213 offset:8640
    v_accvgpr_write_b32 a232, v72
    v_accvgpr_write_b32 a233, v73
    v_accvgpr_write_b32 a234, v74
    v_accvgpr_write_b32 a235, v75
    ds_read_b128 a[116:119], v212 offset:17088
    v_accvgpr_write_b32 a236, v76
    v_accvgpr_write_b32 a237, v77
    v_accvgpr_write_b32 a238, v78
    v_accvgpr_write_b32 a239, v79
    s_branch L_round
L_T:
    s_waitcnt vmcnt(16)
    s_mov_b32 s39, 33792
    s_mul_i32 s44, s28, 20480
    s_add_u32 s44, s44, 80896
    s_cmp_eq_u32 s28, 0
    s_cselect_b32 s44, s39, s44
    v_add_u32 v252, s44, v204
    s_xor_b32 s45, s28, 2
    s_mul_i32 s44, s45, 20480
    s_add_u32 s44, s44, 80896
    s_cmp_eq_u32 s45, 0
    s_cselect_b32 s44, s39, s44
    v_add_u32 v253, s44, v204
    s_lshl_b32 s39, s29, 3
    v_mov_b32 v251, s39
L_isp:
    buffer_load_dword v250, v251, s[76:79], 0 offen sc1
    s_barrier
    ds_write_b128 v252, a[160:163] offset:0
    ds_write_b128 v252, a[164:167] offset:1024
    ds_write_b128 v252, a[168:171] offset:2048
    ds_write_b128 v252, a[172:175] offset:3072
    ds_write_b128 v252, a[176:179] offset:4096
    ds_write_b128 v252, a[180:183] offset:5120
    ds_write_b128 v252, a[184:187] offset:6144
    ds_write_b128 v252, a[188:191] offset:7168
    ds_write_b128 v252, a[192:195] offset:8192
    ds_write_b128 v252, a[196:199] offset:9216
    s_waitcnt lgkmcnt(0)
    ds_write_b128 v252, a[200:203] offset:10240
    ds_write_b128 v252, a[204:207] offset:11264
    ds_write_b128 v252, a[208:211] offset:12288
    ds_write_b128 v252, a[212:215] offset:13312
    ds_write_b128 v252, a[216:219] offset:14336
    ds_write_b128 v252, a[220:223] offset:15360
    ds_write_b128 v252, a[224:227] offset:16384
    ds_write_b128 v252, a[228:231] offset:17408
    ds_write_b128 v252, a[232:235] offset:18432
    ds_write_b128 v252, a[236:239] offset:19456
    s_waitcnt lgkmcnt(0)
    s_barrier
    ds_read_b128 a[0:3], v253 offset:0
    ds_read_b128 a[4:7], v253 offset:1024
    ds_read_b128 a[8:11], v253 offset:2048
    ds_read_b128 a[12:15], v253 offset:3072
    ds_read_b128 a[16:19], v253 offset:4096
    ds_read_b128 a[20:23], v253 offset:5120
    ds_read_b128 a[24:27], v253 offset:6144
    ds_read_b128 a[28:31], v253 offset:7168
    ds_read_b128 a[32:35], v253 offset:8192
    ds_read_b128 a[36:39], v253 offset:9216
    s_waitcnt lgkmcnt(0)
    ds_read_b128 a[40:43], v253 offset:10240
    ds_read_b128 a[44:47], v253 offset:11264
    ds_read_b128 a[48:51], v253 offset:12288
    ds_read_b128 a[52:55], v253 offset:13312
    ds_read_b128 a[56:59], v253 offset:14336
    ds_read_b128 a[60:63], v253 offset:15360
    ds_read_b128 a[64:67], v253 offset:16384
    ds_read_b128 a[68:71], v253 offset:17408
    ds_read_b128 a[72:75], v253 offset:18432
    ds_read_b128 a[76:79], v253 offset:19456
    s_waitcnt lgkmcnt(0)
    s_barrier
    ds_write_b128 v252, v[0:3] offset:0
    ds_write_b128 v252, v[4:7] offset:1024
    ds_write_b128 v252, v[8:11] offset:2048
    ds_write_b128 v252, v[12:15] offset:3072
    ds_write_b128 v252, v[16:19] offset:4096
    ds_write_b128 v252, v[20:23] offset:5120
    ds_write_b128 v252, v[24:27] offset:6144
    ds_write_b128 v252, v[28:31] offset:7168
    ds_write_b128 v252, v[32:35] offset:8192
    ds_write_b128 v252, v[36:39] offset:9216
    s_waitcnt lgkmcnt(0)
    ds_write_b128 v252, v[40:43] offset:10240
    ds_write_b128 v252, v[44:47] offset:11264
    ds_write_b128 v252, v[48:51] offset:12288
    ds_write_b128 v252, v[52:55] offset:13312
    ds_write_b128 v252, v[56:59] offset:14336
    ds_write_b128 v252, v[60:63] offset:15360
    ds_write_b128 v252, v[64:67] offset:16384
    ds_write_b128 v252, v[68:71] offset:17408
    ds_write_b128 v252, v[72:75] offset:18432
    ds_write_b128 v252, v[76:79] offset:19456
    s_waitcnt lgkmcnt(0)
    s_barrier
    ds_read_b128 a[80:83], v253 offset:0
    ds_read_b128 a[84:87], v253 offset:1024
    ds_read_b128 a[88:91], v253 offset:2048
    ds_read_b128 a[92:95], v253 offset:3072
    ds_read_b128 a[96:99], v253 offset:4096
    ds_read_b128 a[100:103], v253 offset:5120
    ds_read_b128 a[104:107], v253 offset:6144
    ds_read_b128 a[108:111], v253 offset:7168
    ds_read_b128 a[112:115], v253 offset:8192
    ds_read_b128 a[116:119], v253 offset:9216
    s_waitcnt lgkmcnt(0)
    ds_read_b128 a[120:123], v253 offset:10240
    ds_read_b128 a[124:127], v253 offset:11264
    ds_read_b128 a[128:131], v253 offset:12288
    ds_read_b128 a[132:135], v253 offset:13312
    ds_read_b128 a[136:139], v253 offset:14336
    ds_read_b128 a[140:143], v253 offset:15360
    ds_read_b128 a[144:147], v253 offset:16384
    ds_read_b128 a[148:151], v253 offset:17408
    ds_read_b128 a[152:155], v253 offset:18432
    ds_read_b128 a[156:159], v253 offset:19456
    s_waitcnt lgkmcnt(0)
    s_waitcnt vmcnt(0)
L_ick:
    v_readfirstlane_b32 s39, v250
    s_nop 1
    s_cmp_eq_u32 s39, 1
    s_cbranch_scc1 L_iok
    s_sleep 8
    buffer_load_dword v250, v251, s[76:79], 0 offen sc1
    s_waitcnt vmcnt(0)
    s_branch L_ick
L_iok:
    s_barrier
    s_lshl_b32 s39, s42, 7
    v_add_u32 v252, s39, v219
    v_add_u32 v253, 67584, v252
    v_add_u32 v254, 33792, v252
    v_add_u32 v255, 101376, v252
    s_add_u32 s43, s37, 33792
    s_mov_b32 s46, s38
    s_call_b64 s[50:51], S_odmb
    v_mov_b32 v246, 2146435072
    v_mov_b32 v247, 2146435072
    v_mov_b32 v248, 2146435072
    v_mov_b32 v222, 2146435072
    s_mov_b32 s31, 0
    s_mov_b32 s58, 0
    s_mov_b32 s55, 0
    s_mov_b32 s56, 0
    s_mov_b32 s59, 0
    s_mov_b32 s47, s38
    s_mov_b32 s48, s37
L_T_loop:
    buffer_load_dword v250, v249, s[68:71], s59 offen sc1
    s_add_u32 s43, s48, 101376
    s_add_u32 s46, s47, 327680
    s_add_u32 s49, s46, 5120
    v_mfma_f32_16x16x32_bf16 v[120:123], a[240:243], a[92:95], v[120:123]
    ds_read_b64_tr_b16 a[248:249], v252 offset:0
    ds_read_b64_tr_b16 a[250:251], v252 offset:256
    v_mfma_f32_16x16x32_bf16 v[128:131], a[240:243], a[108:111], v[128:131]
    ds_read_b64_tr_b16 a[252:253], v252 offset:32
    ds_read_b64_tr_b16 a[254:255], v252 offset:288
    v_mfma_f32_16x16x32_bf16 v[136:139], a[240:243], a[124:127], v[136:139]
    s_add_u32 m0, s43, 0
    v_mfma_f32_16x16x32_bf16 v[144:147], a[240:243], a[140:143], v[144:147]
    buffer_load_dwordx4 v244, s[16:19], s46 offen offset:0 lds
    v_mfma_f32_16x16x32_bf16 v[152:155], a[240:243], a[156:159], v[152:155]
    v_mfma_f32_16x16x32_bf16 v[124:127], a[244:247], a[92:95], v[124:127]
    ds_read_b64_tr_b16 a[240:241], v252 offset:8448
    v_mfma_f32_16x16x32_bf16 v[132:135], a[244:247], a[108:111], v[132:135]
    ds_read_b64_tr_b16 a[242:243], v252 offset:8704
    v_mfma_f32_16x16x32_bf16 v[140:143], a[244:247], a[124:127], v[140:143]
    s_add_u32 m0, s43, 1056
    v_mfma_f32_16x16x32_bf16 v[148:151], a[244:247], a[140:143], v[148:151]
    buffer_load_dwordx4 v244, s[16:19], s49 offen offset:0 lds
    v_mfma_f32_16x16x32_bf16 v[156:159], a[244:247], a[156:159], v[156:159]
    s_waitcnt lgkmcnt(4)
    v_mfma_f32_16x16x32_bf16 v[80:83], a[248:251], a[160:163], 0
    ds_read_b64_tr_b16 a[244:245], v252 offset:8480
    v_mfma_f32_16x16x32_bf16 v[88:91], a[248:251], a[176:179], 0
    ds_read_b64_tr_b16 a[246:247], v252 offset:8736
    v_mfma_f32_16x16x32_bf16 v[96:99], a[248:251], a[192:195], 0
    s_add_u32 m0, s43, 832
    v_mfma_f32_16x16x32_bf16 v[104:107], a[248:251], a[208:211], 0
    v_cvt_pk_bf16_f32 v232, v120, v121
    v_mfma_f32_16x16x32_bf16 v[112:115], a[248:251], a[224:227], 0
    v_cvt_pk_bf16_f32 v233, v122, v123
    s_waitcnt lgkmcnt(4)
    v_mfma_f32_16x16x32_bf16 v[84:87], a[252:255], a[160:163], 0
    ds_read_b64_tr_b16 a[248:249], v252 offset:16896
    v_mfma_f32_16x16x32_bf16 v[92:95], a[252:255], a[176:179], 0
    ds_read_b64_tr_b16 a[250:251], v252 offset:17152
    v_mfma_f32_16x16x32_bf16 v[100:103], a[252:255], a[192:195], 0
    v_cvt_pk_bf16_f32 v234, v124, v125
    v_mfma_f32_16x16x32_bf16 v[108:111], a[252:255], a[208:211], 0
    s_add_u32 s45, s58, 0
    v_cvt_pk_bf16_f32 v235, v126, v127
    v_mfma_f32_16x16x32_bf16 v[116:119], a[252:255], a[224:227], 0
    buffer_store_dwordx4 v[232:235], v246, s[24:27], s45 offen offset:1024 sc1
    s_waitcnt lgkmcnt(2)
    v_mfma_f32_16x16x32_bf16 v[80:83], a[240:243], a[164:167], v[80:83]
    ds_read_b64_tr_b16 a[252:253], v252 offset:16928
    v_mfma_f32_16x16x32_bf16 v[88:91], a[240:243], a[180:183], v[88:91]
    ds_read_b64_tr_b16 a[254:255], v252 offset:17184
    v_mfma_f32_16x16x32_bf16 v[96:99], a[240:243], a[196:199], v[96:99]
    v_cvt_pk_bf16_f32 v236, v128, v129
    v_mfma_f32_16x16x32_bf16 v[104:107], a[240:243], a[212:215], v[104:107]
    v_cvt_pk_bf16_f32 v237, v130, v131
    v_cvt_pk_bf16_f32 v238, v132, v133
    v_mfma_f32_16x16x32_bf16 v[112:115], a[240:243], a[228:231], v[112:115]
    v_cvt_pk_bf16_f32 v239, v134, v135
    v_mfma_f32_16x16x32_bf16 v[84:87], a[244:247], a[164:167], v[84:87]
    s_add_u32 s45, s58, 4096
    ds_read_b64_tr_b16 a[240:241], v252 offset:25344
    v_mfma_f32_16x16x32_bf16 v[92:95], a[244:247], a[180:183], v[92:95]
    ds_read_b64_tr_b16 a[242:243], v252 offset:25600
    v_mfma_f32_16x16x32_bf16 v[100:103], a[244:247], a[196:199], v[100:103]
    buffer_store_dwordx4 v[236:239], v246, s[24:27], s45 offen offset:1024 sc1
    v_cvt_pk_bf16_f32 v232, v136, v137
    v_mfma_f32_16x16x32_bf16 v[108:111], a[244:247], a[212:215], v[108:111]
    v_cvt_pk_bf16_f32 v233, v138, v139
    v_mfma_f32_16x16x32_bf16 v[116:119], a[244:247], a[228:231], v[116:119]
    s_waitcnt lgkmcnt(2)
    v_mfma_f32_16x16x32_bf16 v[80:83], a[248:251], a[168:171], v[80:83]
    ds_read_b64_tr_b16 a[244:245], v252 offset:25376
    v_mfma_f32_16x16x32_bf16 v[88:91], a[248:251], a[184:187], v[88:91]
    ds_read_b64_tr_b16 a[246:247], v252 offset:25632
    v_cvt_pk_bf16_f32 v234, v140, v141
    v_mfma_f32_16x16x32_bf16 v[96:99], a[248:251], a[200:203], v[96:99]
    v_cvt_pk_bf16_f32 v235, v142, v143
    v_mfma_f32_16x16x32_bf16 v[104:107], a[248:251], a[216:219], v[104:107]
    s_add_u32 s45, s58, 8192
    buffer_store_dwordx4 v[232:235], v246, s[24:27], s45 offen offset:1024 sc1
    v_mfma_f32_16x16x32_bf16 v[112:115], a[248:251], a[232:235], v[112:115]
    v_cvt_pk_bf16_f32 v236, v144, v145
    v_mfma_f32_16x16x32_bf16 v[84:87], a[252:255], a[168:171], v[84:87]
    ds_read_b64_tr_b16 a[248:249], v252 offset:64
    v_mfma_f32_16x16x32_bf16 v[92:95], a[252:255], a[184:187], v[92:95]
    ds_read_b64_tr_b16 a[250:251], v252 offset:320
    v_cvt_pk_bf16_f32 v237, v146, v147
    v_mfma_f32_16x16x32_bf16 v[100:103], a[252:255], a[200:203], v[100:103]
    v_cvt_pk_bf16_f32 v238, v148, v149
    v_mfma_f32_16x16x32_bf16 v[108:111], a[252:255], a[216:219], v[108:111]
    s_add_u32 s45, s58, 12288
    v_cvt_pk_bf16_f32 v239, v150, v151
    v_mfma_f32_16x16x32_bf16 v[116:119], a[252:255], a[232:235], v[116:119]
    s_waitcnt lgkmcnt(2)
    v_mfma_f32_16x16x32_bf16 v[80:83], a[240:243], a[172:175], v[80:83]
    ds_read_b64_tr_b16 a[252:253], v252 offset:96
    v_mfma_f32_16x16x32_bf16 v[88:91], a[240:243], a[188:191], v[88:91]
    ds_read_b64_tr_b16 a[254:255], v252 offset:352
    buffer_store_dwordx4 v[236:239], v246, s[24:27], s45 offen offset:1024 sc1
    v_mfma_f32_16x16x32_bf16 v[96:99], a[240:243], a[204:207], v[96:99]
    v_cvt_pk_bf16_f32 v232, v152, v153
    v_mfma_f32_16x16x32_bf16 v[104:107], a[240:243], a[220:223], v[104:107]
    v_cvt_pk_bf16_f32 v233, v154, v155
    v_mfma_f32_16x16x32_bf16 v[112:115], a[240:243], a[236:239], v[112:115]
    v_cvt_pk_bf16_f32 v234, v156, v157
    v_cvt_pk_bf16_f32 v235, v158, v159
    v_mfma_f32_16x16x32_bf16 v[84:87], a[244:247], a[172:175], v[84:87]
    ds_read_b64_tr_b16 a[240:241], v252 offset:8512
    v_mfma_f32_16x16x32_bf16 v[92:95], a[244:247], a[188:191], v[92:95]
    s_add_u32 s45, s58, 16384
    ds_read_b64_tr_b16 a[242:243], v252 offset:8768
    v_mfma_f32_16x16x32_bf16 v[100:103], a[244:247], a[204:207], v[100:103]
    buffer_store_dwordx4 v[232:235], v246, s[24:27], s45 offen offset:1024 sc1
    v_mfma_f32_16x16x32_bf16 v[108:111], a[244:247], a[220:223], v[108:111]
    s_mul_i32 s58, s31, 40960
    v_mov_b32 v246, v245
    v_mfma_f32_16x16x32_bf16 v[116:119], a[244:247], a[236:239], v[116:119]
    s_waitcnt lgkmcnt(2)
    v_mfma_f32_16x16x32_bf16 v[120:123], a[248:251], a[160:163], 0
    ds_read_b64_tr_b16 a[244:245], v252 offset:8544
    v_mfma_f32_16x16x32_bf16 v[128:131], a[248:251], a[176:179], 0
    ds_read_b64_tr_b16 a[246:247], v252 offset:8800
    v_mfma_f32_16x16x32_bf16 v[136:139], a[248:251], a[192:195], 0
    s_waitcnt vmcnt(32)
    v_mfma_f32_16x16x32_bf16 v[144:147], a[248:251], a[208:211], 0
    buffer_load_dwordx4 v244, s[16:19], s46 offen offset:1280 lds
    v_mfma_f32_16x16x32_bf16 v[152:155], a[248:251], a[224:227], 0
    s_add_u32 m0, s43, 1888
    v_mfma_f32_16x16x32_bf16 v[200:203], v[224:227], v[160:163], 0
    v_mfma_f32_16x16x32_bf16 v[124:127], a[252:255], a[160:163], 0
    ds_read_b64_tr_b16 a[248:249], v252 offset:16960
    v_mfma_f32_16x16x32_bf16 v[132:135], a[252:255], a[176:179], 0
    ds_read_b64_tr_b16 a[250:251], v252 offset:17216
    v_mfma_f32_16x16x32_bf16 v[140:143], a[252:255], a[192:195], 0
    v_mfma_f32_16x16x32_bf16 v[200:203], v[224:227], v[164:167], v[200:203]
    v_mfma_f32_16x16x32_bf16 v[148:151], a[252:255], a[208:211], 0
    buffer_load_dwordx4 v244, s[16:19], s49 offen offset:1280 lds
    v_mfma_f32_16x16x32_bf16 v[200:203], v[228:231], v[168:171], v[200:203]
    v_mfma_f32_16x16x32_bf16 v[156:159], a[252:255], a[224:227], 0
    s_waitcnt lgkmcnt(2)
    v_mfma_f32_16x16x32_bf16 v[120:123], a[240:243], a[164:167], v[120:123]
    ds_read_b64_tr_b16 a[252:253], v252 offset:16992
    v_mfma_f32_16x16x32_bf16 v[128:131], a[240:243], a[180:183], v[128:131]
    ds_read_b64_tr_b16 a[254:255], v252 offset:17248
    v_mfma_f32_16x16x32_bf16 v[136:139], a[240:243], a[196:199], v[136:139]
    s_add_u32 m0, s43, 1664
    v_mfma_f32_16x16x32_bf16 v[200:203], v[228:231], v[172:175], v[200:203]
    v_mfma_f32_16x16x32_bf16 v[144:147], a[240:243], a[212:215], v[144:147]
    buffer_load_dwordx4 v244, s[16:19], s46 offen offset:2560 lds
    v_mfma_f32_16x16x32_bf16 v[152:155], a[240:243], a[228:231], v[152:155]
    v_mfma_f32_16x16x32_bf16 v[204:207], v[224:227], v[176:179], 0
    v_mfma_f32_16x16x32_bf16 v[124:127], a[244:247], a[164:167], v[124:127]
    ds_read_b64_tr_b16 a[240:241], v252 offset:25408
    v_mfma_f32_16x16x32_bf16 v[132:135], a[244:247], a[180:183], v[132:135]
    ds_read_b64_tr_b16 a[242:243], v252 offset:25664
    v_mfma_f32_16x16x32_bf16 v[140:143], a[244:247], a[196:199], v[140:143]
    s_add_u32 m0, s43, 2720
    v_mfma_f32_16x16x32_bf16 v[204:207], v[224:227], v[180:183], v[204:207]
    v_mfma_f32_16x16x32_bf16 v[148:151], a[244:247], a[212:215], v[148:151]
    buffer_load_dwordx4 v244, s[16:19], s49 offen offset:2560 lds
    v_mfma_f32_16x16x32_bf16 v[156:159], a[244:247], a[228:231], v[156:159]
    s_waitcnt lgkmcnt(2)
    v_mfma_f32_16x16x32_bf16 v[120:123], a[248:251], a[168:171], v[120:123]
    ds_read_b64_tr_b16 a[244:245], v252 offset:25440
    v_mfma_f32_16x16x32_bf16 v[128:131], a[248:251], a[184:187], v[128:131]
    ds_read_b64_tr_b16 a[246:247], v252 offset:25696
    v_mfma_f32_16x16x32_bf16 v[136:139], a[248:251], a[200:203], v[136:139]
    s_add_u32 m0, s43, 2496
    v_mfma_f32_16x16x32_bf16 v[204:207], v[228:231], v[184:187], v[204:207]
    v_mfma_f32_16x16x32_bf16 v[144:147], a[248:251], a[216:219], v[144:147]
    v_mfma_f32_16x16x32_bf16 v[204:207], v[228:231], v[188:191], v[204:207]
    v_mfma_f32_16x16x32_bf16 v[152:155], a[248:251], a[232:235], v[152:155]
    buffer_load_dwordx4 v244, s[16:19], s46 offen offset:3840 lds
    v_mfma_f32_16x16x32_bf16 v[124:127], a[252:255], a[168:171], v[124:127]
    s_add_u32 m0, s43, 3552
    v_mfma_f32_16x16x32_bf16 v[208:211], v[224:227], v[192:195], 0
    v_mfma_f32_16x16x32_bf16 v[132:135], a[252:255], a[184:187], v[132:135]
    v_mfma_f32_16x16x32_bf16 v[208:211], v[224:227], v[196:199], v[208:211]
    v_mfma_f32_16x16x32_bf16 v[140:143], a[252:255], a[200:203], v[140:143]
    buffer_load_dwordx4 v244, s[16:19], s49 offen offset:3840 lds
    v_mfma_f32_16x16x32_bf16 v[148:151], a[252:255], a[216:219], v[148:151]
    v_mfma_f32_16x16x32_bf16 v[156:159], a[252:255], a[232:235], v[156:159]
    s_waitcnt vmcnt(27)
    s_waitcnt lgkmcnt(0)
    s_barrier
    s_add_u32 s47, s47, 256
    s_cmp_ge_u32 s31, 2
    s_cbranch_scc1 L_T_ck
L_T_ckb:
    s_add_u32 s43, s48, 0
    s_add_u32 s46, s47, 0
    s_add_u32 s49, s46, 5120
    v_mfma_f32_16x16x32_bf16 v[120:123], a[240:243], a[172:175], v[120:123]
    ds_read_b64_tr_b16 a[248:249], v253 offset:0
    ds_read_b64_tr_b16 a[250:251], v253 offset:256
    v_mfma_f32_16x16x32_bf16 v[128:131], a[240:243], a[188:191], v[128:131]
    ds_read_b64_tr_b16 a[252:253], v253 offset:32
    ds_read_b64_tr_b16 a[254:255], v253 offset:288
    v_mfma_f32_16x16x32_bf16 v[136:139], a[240:243], a[204:207], v[136:139]
    s_add_u32 m0, s43, 0
    v_mfma_f32_16x16x32_bf16 v[144:147], a[240:243], a[220:223], v[144:147]
    buffer_load_dwordx4 v243, s[16:19], s46 offen offset:0 lds
    v_mfma_f32_16x16x32_bf16 v[152:155], a[240:243], a[236:239], v[152:155]
    s_add_u32 m0, s43, 1056
    v_mfma_f32_16x16x32_bf16 v[124:127], a[244:247], a[172:175], v[124:127]
    ds_read_b64_tr_b16 a[240:241], v253 offset:8448
    v_mfma_f32_16x16x32_bf16 v[132:135], a[244:247], a[188:191], v[132:135]
    ds_read_b64_tr_b16 a[242:243], v253 offset:8704
    v_mfma_f32_16x16x32_bf16 v[140:143], a[244:247], a[204:207], v[140:143]
    buffer_load_dwordx4 v243, s[16:19], s49 offen offset:0 lds
    v_mfma_f32_16x16x32_bf16 v[148:151], a[244:247], a[220:223], v[148:151]
    s_add_u32 m0, s43, 832
    v_mfma_f32_16x16x32_bf16 v[156:159], a[244:247], a[236:239], v[156:159]
    s_waitcnt lgkmcnt(4)
    v_mfma_f32_16x16x32_bf16 v[80:83], a[248:251], v[0:3], v[80:83]
    ds_read_b64_tr_b16 a[244:245], v253 offset:8480
    v_mfma_f32_16x16x32_bf16 v[88:91], a[248:251], v[16:19], v[88:91]
    ds_read_b64_tr_b16 a[246:247], v253 offset:8736
    v_mfma_f32_16x16x32_bf16 v[96:99], a[248:251], v[32:35], v[96:99]
    buffer_load_dwordx4 v243, s[16:19], s46 offen offset:1280 lds
    v_mfma_f32_16x16x32_bf16 v[104:107], a[248:251], v[48:51], v[104:107]
    s_add_u32 m0, s43, 1888
    v_mfma_f32_16x16x32_bf16 v[112:115], a[248:251], v[64:67], v[112:115]
    s_waitcnt lgkmcnt(4)
    v_mfma_f32_16x16x32_bf16 v[84:87], a[252:255], v[0:3], v[84:87]
    ds_read_b64_tr_b16 a[248:249], v253 offset:16896
    v_mfma_f32_16x16x32_bf16 v[92:95], a[252:255], v[16:19], v[92:95]
    ds_read_b64_tr_b16 a[250:251], v253 offset:17152
    v_mfma_f32_16x16x32_bf16 v[100:103], a[252:255], v[32:35], v[100:103]
    v_mfma_f32_16x16x32_bf16 v[108:111], a[252:255], v[48:51], v[108:111]
    buffer_load_dwordx4 v243, s[16:19], s49 offen offset:1280 lds
    v_mfma_f32_16x16x32_bf16 v[116:119], a[252:255], v[64:67], v[116:119]
    s_waitcnt lgkmcnt(2)
    v_mfma_f32_16x16x32_bf16 v[80:83], a[240:243], v[4:7], v[80:83]
    ds_read_b64_tr_b16 a[252:253], v253 offset:16928
    v_mfma_f32_16x16x32_bf16 v[88:91], a[240:243], v[20:23], v[88:91]
    ds_read_b64_tr_b16 a[254:255], v253 offset:17184
    v_mfma_f32_16x16x32_bf16 v[96:99], a[240:243], v[36:39], v[96:99]
    s_add_u32 m0, s43, 1664
    v_mfma_f32_16x16x32_bf16 v[104:107], a[240:243], v[52:55], v[104:107]
    buffer_load_dwordx4 v243, s[16:19], s46 offen offset:2560 lds
    v_mfma_f32_16x16x32_bf16 v[112:115], a[240:243], v[68:71], v[112:115]
    s_add_u32 m0, s43, 2720
    v_mfma_f32_16x16x32_bf16 v[84:87], a[244:247], v[4:7], v[84:87]
    ds_read_b64_tr_b16 a[240:241], v253 offset:25344
    v_mfma_f32_16x16x32_bf16 v[92:95], a[244:247], v[20:23], v[92:95]
    ds_read_b64_tr_b16 a[242:243], v253 offset:25600
    v_mfma_f32_16x16x32_bf16 v[100:103], a[244:247], v[36:39], v[100:103]
    buffer_load_dwordx4 v243, s[16:19], s49 offen offset:2560 lds
    v_mfma_f32_16x16x32_bf16 v[108:111], a[244:247], v[52:55], v[108:111]
    s_add_u32 m0, s43, 2496
    v_mfma_f32_16x16x32_bf16 v[116:119], a[244:247], v[68:71], v[116:119]
    s_waitcnt lgkmcnt(2)
    v_mfma_f32_16x16x32_bf16 v[80:83], a[248:251], v[8:11], v[80:83]
    ds_read_b64_tr_b16 a[244:245], v253 offset:25376
    v_mfma_f32_16x16x32_bf16 v[88:91], a[248:251], v[24:27], v[88:91]
    ds_read_b64_tr_b16 a[246:247], v253 offset:25632
    v_mfma_f32_16x16x32_bf16 v[96:99], a[248:251], v[40:43], v[96:99]
    buffer_load_dwordx4 v243, s[16:19], s46 offen offset:3840 lds
    v_mfma_f32_16x16x32_bf16 v[104:107], a[248:251], v[56:59], v[104:107]
    s_add_u32 m0, s43, 3552
    v_mfma_f32_16x16x32_bf16 v[112:115], a[248:251], v[72:75], v[112:115]
    buffer_load_dwordx4 v243, s[16:19], s49 offen offset:3840 lds
    v_mfma_f32_16x16x32_bf16 v[84:87], a[252:255], v[8:11], v[84:87]
    ds_read_b64_tr_b16 a[248:249], v253 offset:64
    v_mfma_f32_16x16x32_bf16 v[92:95], a[252:255], v[24:27], v[92:95]
    ds_read_b64_tr_b16 a[250:251], v253 offset:320
    v_mfma_f32_16x16x32_bf16 v[100:103], a[252:255], v[40:43], v[100:103]
    v_mfma_f32_16x16x32_bf16 v[108:111], a[252:255], v[56:59], v[108:111]
    s_add_u32 s39, s55, 0
    v_mfma_f32_16x16x32_bf16 v[116:119], a[252:255], v[72:75], v[116:119]
    s_waitcnt lgkmcnt(2)
    v_mfma_f32_16x16x32_bf16 v[80:83], a[240:243], v[12:15], v[80:83]
    ds_read_b64_tr_b16 a[252:253], v253 offset:96
    v_mfma_f32_16x16x32_bf16 v[88:91], a[240:243], v[28:31], v[88:91]
    ds_read_b64_tr_b16 a[254:255], v253 offset:352
    v_mfma_f32_16x16x32_bf16 v[96:99], a[240:243], v[44:47], v[96:99]
    buffer_load_dwordx4 v[160:163], v247, s[60:63], s39 offen sc1
    v_mfma_f32_16x16x32_bf16 v[104:107], a[240:243], v[60:63], v[104:107]
    s_add_u32 s39, s55, 819200
    v_mfma_f32_16x16x32_bf16 v[112:115], a[240:243], v[76:79], v[112:115]
    buffer_load_dwordx4 v[164:167], v247, s[60:63], s39 offen sc1
    v_mfma_f32_16x16x32_bf16 v[84:87], a[244:247], v[12:15], v[84:87]
    ds_read_b64_tr_b16 a[240:241], v253 offset:8512
    v_mfma_f32_16x16x32_bf16 v[92:95], a[244:247], v[28:31], v[92:95]
    ds_read_b64_tr_b16 a[242:243], v253 offset:8768
    v_mfma_f32_16x16x32_bf16 v[100:103], a[244:247], v[44:47], v[100:103]
    s_add_u32 s39, s55, 4096
    v_mfma_f32_16x16x32_bf16 v[108:111], a[244:247], v[60:63], v[108:111]
    buffer_load_dwordx4 v[168:171], v247, s[60:63], s39 offen sc1
    v_mfma_f32_16x16x32_bf16 v[116:119], a[244:247], v[76:79], v[116:119]
    s_waitcnt lgkmcnt(2)
    v_mfma_f32_16x16x32_bf16 v[120:123], a[248:251], v[0:3], v[120:123]
    ds_read_b64_tr_b16 a[244:245], v253 offset:8544
    v_mfma_f32_16x16x32_bf16 v[128:131], a[248:251], v[16:19], v[128:131]
    ds_read_b64_tr_b16 a[246:247], v253 offset:8800
    v_mfma_f32_16x16x32_bf16 v[136:139], a[248:251], v[32:35], v[136:139]
    s_add_u32 s39, s55, 823296
    v_mfma_f32_16x16x32_bf16 v[144:147], a[248:251], v[48:51], v[144:147]
    buffer_load_dwordx4 v[172:175], v247, s[60:63], s39 offen sc1
    v_mfma_f32_16x16x32_bf16 v[152:155], a[248:251], v[64:67], v[152:155]
    s_add_u32 s39, s55, 8192
    v_mfma_f32_16x16x32_bf16 v[124:127], a[252:255], v[0:3], v[124:127]
    ds_read_b64_tr_b16 a[248:249], v253 offset:16960
    v_mfma_f32_16x16x32_bf16 v[132:135], a[252:255], v[16:19], v[132:135]
    ds_read_b64_tr_b16 a[250:251], v253 offset:17216
    v_mfma_f32_16x16x32_bf16 v[140:143], a[252:255], v[32:35], v[140:143]
    v_mfma_f32_16x16x32_bf16 v[148:151], a[252:255], v[48:51], v[148:151]
    buffer_load_dwordx4 v[176:179], v247, s[60:63], s39 offen sc1
    v_mfma_f32_16x16x32_bf16 v[156:159], a[252:255], v[64:67], v[156:159]
    s_waitcnt lgkmcnt(2)
    v_mfma_f32_16x16x32_bf16 v[120:123], a[240:243], v[4:7], v[120:123]
    ds_read_b64_tr_b16 a[252:253], v253 offset:16992
    v_mfma_f32_16x16x32_bf16 v[128:131], a[240:243], v[20:23], v[128:131]
    ds_read_b64_tr_b16 a[254:255], v253 offset:17248
    v_mfma_f32_16x16x32_bf16 v[136:139], a[240:243], v[36:39], v[136:139]
    s_add_u32 s39, s55, 827392
    v_mfma_f32_16x16x32_bf16 v[144:147], a[240:243], v[52:55], v[144:147]
    buffer_load_dwordx4 v[180:183], v247, s[60:63], s39 offen sc1
    v_mfma_f32_16x16x32_bf16 v[152:155], a[240:243], v[68:71], v[152:155]
    s_add_u32 s39, s55, 12288
    v_mfma_f32_16x16x32_bf16 v[124:127], a[244:247], v[4:7], v[124:127]
    ds_read_b64_tr_b16 a[240:241], v253 offset:25408
    v_mfma_f32_16x16x32_bf16 v[132:135], a[244:247], v[20:23], v[132:135]
    ds_read_b64_tr_b16 a[242:243], v253 offset:25664
    v_mfma_f32_16x16x32_bf16 v[140:143], a[244:247], v[36:39], v[140:143]
    buffer_load_dwordx4 v[184:187], v247, s[60:63], s39 offen sc1
    v_mfma_f32_16x16x32_bf16 v[148:151], a[244:247], v[52:55], v[148:151]
    s_add_u32 s39, s55, 831488
    v_mfma_f32_16x16x32_bf16 v[156:159], a[244:247], v[68:71], v[156:159]
    s_waitcnt lgkmcnt(2)
    v_mfma_f32_16x16x32_bf16 v[120:123], a[248:251], v[8:11], v[120:123]
    ds_read_b64_tr_b16 a[244:245], v253 offset:25440
    v_mfma_f32_16x16x32_bf16 v[128:131], a[248:251], v[24:27], v[128:131]
    ds_read_b64_tr_b16 a[246:247], v253 offset:25696
    v_mfma_f32_16x16x32_bf16 v[136:139], a[248:251], v[40:43], v[136:139]
    buffer_load_dwordx4 v[188:191], v247, s[60:63], s39 offen sc1
    v_mfma_f32_16x16x32_bf16 v[144:147], a[248:251], v[56:59], v[144:147]
    s_add_u32 s39, s55, 16384
    v_mfma_f32_16x16x32_bf16 v[152:155], a[248:251], v[72:75], v[152:155]
    buffer_load_dwordx4 v[192:195], v247, s[60:63], s39 offen sc1
    v_mfma_f32_16x16x32_bf16 v[124:127], a[252:255], v[8:11], v[124:127]
    v_mfma_f32_16x16x32_bf16 v[132:135], a[252:255], v[24:27], v[132:135]
    s_add_u32 s39, s55, 835584
    v_mfma_f32_16x16x32_bf16 v[140:143], a[252:255], v[40:43], v[140:143]
    buffer_load_dwordx4 v[196:199], v247, s[60:63], s39 offen sc1
    v_mfma_f32_16x16x32_bf16 v[148:151], a[252:255], v[56:59], v[148:151]
    v_mfma_f32_16x16x32_bf16 v[156:159], a[252:255], v[72:75], v[156:159]
    s_waitcnt vmcnt(24)
    s_waitcnt lgkmcnt(0)
    s_barrier
    s_lshl_b32 s44, s31, 7
    s_sub_u32 s44, s44, 128
    s_cbranch_scc1 L_T_np
    s_call_b64 s[50:51], S_post
L_T_np:
    s_add_u32 s43, s48, 67584
    s_add_u32 s46, s47, 327680
    s_add_u32 s49, s46, 5120
    v_mfma_f32_16x16x32_bf16 v[120:123], a[240:243], v[12:15], v[120:123]
    ds_read_b64_tr_b16 a[248:249], v254 offset:0
    ds_read_b64_tr_b16 a[250:251], v254 offset:256
    v_mfma_f32_16x16x32_bf16 v[128:131], a[240:243], v[28:31], v[128:131]
    ds_read_b64_tr_b16 a[252:253], v254 offset:32
    ds_read_b64_tr_b16 a[254:255], v254 offset:288
    v_mfma_f32_16x16x32_bf16 v[136:139], a[240:243], v[44:47], v[136:139]
    s_add_u32 m0, s43, 0
    v_mfma_f32_16x16x32_bf16 v[144:147], a[240:243], v[60:63], v[144:147]
    v_mfma_f32_16x16x32_bf16 v[152:155], a[240:243], v[76:79], v[152:155]
    v_cvt_pk_bf16_f32 v200, v200, v201
    v_mfma_f32_16x16x32_bf16 v[124:127], a[244:247], v[12:15], v[124:127]
    ds_read_b64_tr_b16 a[240:241], v254 offset:8448
    v_mfma_f32_16x16x32_bf16 v[132:135], a[244:247], v[28:31], v[132:135]
    ds_read_b64_tr_b16 a[242:243], v254 offset:8704
    v_mfma_f32_16x16x32_bf16 v[140:143], a[244:247], v[44:47], v[140:143]
    buffer_load_dwordx4 v243, s[16:19], s46 offen offset:0 lds
    v_mfma_f32_16x16x32_bf16 v[148:151], a[244:247], v[60:63], v[148:151]
    v_mfma_f32_16x16x32_bf16 v[156:159], a[244:247], v[76:79], v[156:159]
    s_waitcnt lgkmcnt(4)
    v_mfma_f32_16x16x32_bf16 v[80:83], a[248:251], a[0:3], v[80:83]
    ds_read_b64_tr_b16 a[244:245], v254 offset:8480
    v_mfma_f32_16x16x32_bf16 v[88:91], a[248:251], a[16:19], v[88:91]
    ds_read_b64_tr_b16 a[246:247], v254 offset:8736
    v_mfma_f32_16x16x32_bf16 v[96:99], a[248:251], a[32:35], v[96:99]
    s_add_u32 m0, s43, 1056
    v_mfma_f32_16x16x32_bf16 v[104:107], a[248:251], a[48:51], v[104:107]
    v_cvt_pk_bf16_f32 v201, v202, v203
    v_mfma_f32_16x16x32_bf16 v[112:115], a[248:251], a[64:67], v[112:115]
    s_waitcnt lgkmcnt(4)
    v_mfma_f32_16x16x32_bf16 v[84:87], a[252:255], a[0:3], v[84:87]
    ds_read_b64_tr_b16 a[248:249], v254 offset:16896
    v_mfma_f32_16x16x32_bf16 v[92:95], a[252:255], a[16:19], v[92:95]
    ds_read_b64_tr_b16 a[250:251], v254 offset:17152
    v_mfma_f32_16x16x32_bf16 v[100:103], a[252:255], a[32:35], v[100:103]
    v_mfma_f32_16x16x32_bf16 v[108:111], a[252:255], a[48:51], v[108:111]
    buffer_load_dwordx4 v243, s[16:19], s49 offen offset:0 lds
    v_mfma_f32_16x16x32_bf16 v[116:119], a[252:255], a[64:67], v[116:119]
    s_waitcnt lgkmcnt(2)
    v_mfma_f32_16x16x32_bf16 v[80:83], a[240:243], a[4:7], v[80:83]
    ds_read_b64_tr_b16 a[252:253], v254 offset:16928
    v_mfma_f32_16x16x32_bf16 v[88:91], a[240:243], a[20:23], v[88:91]
    ds_read_b64_tr_b16 a[254:255], v254 offset:17184
    v_mfma_f32_16x16x32_bf16 v[96:99], a[240:243], a[36:39], v[96:99]
    s_add_u32 s44, s56, 0
    v_mfma_f32_16x16x32_bf16 v[104:107], a[240:243], a[52:55], v[104:107]
    s_add_u32 m0, s43, 832
    v_mfma_f32_16x16x32_bf16 v[112:115], a[240:243], a[68:71], v[112:115]
    buffer_store_dwordx2 v[200:201], v248, s[72:75], s44 offen
    v_mfma_f32_16x16x32_bf16 v[84:87], a[244:247], a[4:7], v[84:87]
    ds_read_b64_tr_b16 a[240:241], v254 offset:25344
    v_mfma_f32_16x16x32_bf16 v[92:95], a[244:247], a[20:23], v[92:95]
    ds_read_b64_tr_b16 a[242:243], v254 offset:25600
    v_mfma_f32_16x16x32_bf16 v[100:103], a[244:247], a[36:39], v[100:103]
    v_mfma_f32_16x16x32_bf16 v[108:111], a[244:247], a[52:55], v[108:111]
    buffer_load_dwordx4 v243, s[16:19], s46 offen offset:1280 lds
    v_mfma_f32_16x16x32_bf16 v[116:119], a[244:247], a[68:71], v[116:119]
    s_waitcnt lgkmcnt(2)
    v_mfma_f32_16x16x32_bf16 v[80:83], a[248:251], a[8:11], v[80:83]
    ds_read_b64_tr_b16 a[244:245], v254 offset:25376
    v_mfma_f32_16x16x32_bf16 v[88:91], a[248:251], a[24:27], v[88:91]
    ds_read_b64_tr_b16 a[246:247], v254 offset:25632
    v_mfma_f32_16x16x32_bf16 v[96:99], a[248:251], a[40:43], v[96:99]
    v_mfma_f32_16x16x32_bf16 v[104:107], a[248:251], a[56:59], v[104:107]
    s_add_u32 m0, s43, 1888
    v_mfma_f32_16x16x32_bf16 v[112:115], a[248:251], a[72:75], v[112:115]
    v_cvt_pk_bf16_f32 v204, v204, v205
    v_mfma_f32_16x16x32_bf16 v[84:87], a[252:255], a[8:11], v[84:87]
    ds_read_b64_tr_b16 a[248:249], v254 offset:64
    v_mfma_f32_16x16x32_bf16 v[92:95], a[252:255], a[24:27], v[92:95]
    ds_read_b64_tr_b16 a[250:251], v254 offset:320
    v_mfma_f32_16x16x32_bf16 v[100:103], a[252:255], a[40:43], v[100:103]
    v_mfma_f32_16x16x32_bf16 v[108:111], a[252:255], a[56:59], v[108:111]
    buffer_load_dwordx4 v243, s[16:19], s49 offen offset:1280 lds
    v_mfma_f32_16x16x32_bf16 v[116:119], a[252:255], a[72:75], v[116:119]
    s_waitcnt lgkmcnt(2)
    v_mfma_f32_16x16x32_bf16 v[80:83], a[240:243], a[12:15], v[80:83]
    ds_read_b64_tr_b16 a[252:253], v254 offset:96
    v_mfma_f32_16x16x32_bf16 v[88:91], a[240:243], a[28:31], v[88:91]
    ds_read_b64_tr_b16 a[254:255], v254 offset:352
    v_mfma_f32_16x16x32_bf16 v[96:99], a[240:243], a[44:47], v[96:99]
    v_cvt_pk_bf16_f32 v205, v206, v207
    v_mfma_f32_16x16x32_bf16 v[104:107], a[240:243], a[60:63], v[104:107]
    s_add_u32 m0, s43, 1664
    v_mfma_f32_16x16x32_bf16 v[112:115], a[240:243], a[76:79], v[112:115]
    v_mfma_f32_16x16x32_bf16 v[84:87], a[244:247], a[12:15], v[84:87]
    ds_read_b64_tr_b16 a[240:241], v254 offset:8512
    v_mfma_f32_16x16x32_bf16 v[92:95], a[244:247], a[28:31], v[92:95]
    ds_read_b64_tr_b16 a[242:243], v254 offset:8768
    v_mfma_f32_16x16x32_bf16 v[100:103], a[244:247], a[44:47], v[100:103]
    s_add_u32 s44, s56, 40960
    v_mfma_f32_16x16x32_bf16 v[108:111], a[244:247], a[60:63], v[108:111]
    buffer_load_dwordx4 v243, s[16:19], s46 offen offset:2560 lds
    v_mfma_f32_16x16x32_bf16 v[116:119], a[244:247], a[76:79], v[116:119]
    s_waitcnt lgkmcnt(2)
    v_mfma_f32_16x16x32_bf16 v[120:123], a[248:251], a[0:3], v[120:123]
    ds_read_b64_tr_b16 a[244:245], v254 offset:8544
    v_mfma_f32_16x16x32_bf16 v[128:131], a[248:251], a[16:19], v[128:131]
    ds_read_b64_tr_b16 a[246:247], v254 offset:8800
    v_mfma_f32_16x16x32_bf16 v[136:139], a[248:251], a[32:35], v[136:139]
    buffer_store_dwordx2 v[204:205], v248, s[72:75], s44 offen
    v_mfma_f32_16x16x32_bf16 v[144:147], a[248:251], a[48:51], v[144:147]
    s_add_u32 m0, s43, 2720
    v_mfma_f32_16x16x32_bf16 v[152:155], a[248:251], a[64:67], v[152:155]
    v_mfma_f32_16x16x32_bf16 v[124:127], a[252:255], a[0:3], v[124:127]
    ds_read_b64_tr_b16 a[248:249], v254 offset:16960
    v_mfma_f32_16x16x32_bf16 v[132:135], a[252:255], a[16:19], v[132:135]
    ds_read_b64_tr_b16 a[250:251], v254 offset:17216
    v_mfma_f32_16x16x32_bf16 v[140:143], a[252:255], a[32:35], v[140:143]
    v_mfma_f32_16x16x32_bf16 v[148:151], a[252:255], a[48:51], v[148:151]
    buffer_load_dwordx4 v243, s[16:19], s49 offen offset:2560 lds
    v_mfma_f32_16x16x32_bf16 v[156:159], a[252:255], a[64:67], v[156:159]
    s_waitcnt lgkmcnt(2)
    v_mfma_f32_16x16x32_bf16 v[120:123], a[240:243], a[4:7], v[120:123]
    ds_read_b64_tr_b16 a[252:253], v254 offset:16992
    v_mfma_f32_16x16x32_bf16 v[128:131], a[240:243], a[20:23], v[128:131]
    ds_read_b64_tr_b16 a[254:255], v254 offset:17248
    v_mfma_f32_16x16x32_bf16 v[136:139], a[240:243], a[36:39], v[136:139]
    v_cvt_pk_bf16_f32 v208, v208, v209
    v_mfma_f32_16x16x32_bf16 v[144:147], a[240:243], a[52:55], v[144:147]
    s_add_u32 m0, s43, 2496
    v_mfma_f32_16x16x32_bf16 v[152:155], a[240:243], a[68:71], v[152:155]
    v_mfma_f32_16x16x32_bf16 v[124:127], a[244:247], a[4:7], v[124:127]
    ds_read_b64_tr_b16 a[240:241], v254 offset:25408
    v_mfma_f32_16x16x32_bf16 v[132:135], a[244:247], a[20:23], v[132:135]
    ds_read_b64_tr_b16 a[242:243], v254 offset:25664
    v_mfma_f32_16x16x32_bf16 v[140:143], a[244:247], a[36:39], v[140:143]
    v_cvt_pk_bf16_f32 v209, v210, v211
    v_mfma_f32_16x16x32_bf16 v[148:151], a[244:247], a[52:55], v[148:151]
    buffer_load_dwordx4 v243, s[16:19], s46 offen offset:3840 lds
    v_mfma_f32_16x16x32_bf16 v[156:159], a[244:247], a[68:71], v[156:159]
    s_waitcnt lgkmcnt(2)
    v_mfma_f32_16x16x32_bf16 v[120:123], a[248:251], a[8:11], v[120:123]
    ds_read_b64_tr_b16 a[244:245], v254 offset:25440
    v_mfma_f32_16x16x32_bf16 v[128:131], a[248:251], a[24:27], v[128:131]
    ds_read_b64_tr_b16 a[246:247], v254 offset:25696
    v_mfma_f32_16x16x32_bf16 v[136:139], a[248:251], a[40:43], v[136:139]
    v_mfma_f32_16x16x32_bf16 v[144:147], a[248:251], a[56:59], v[144:147]
    s_add_u32 m0, s43, 3552
    v_mfma_f32_16x16x32_bf16 v[152:155], a[248:251], a[72:75], v[152:155]
    s_add_u32 s44, s56, 81920
    v_mfma_f32_16x16x32_bf16 v[124:127], a[252:255], a[8:11], v[124:127]
    buffer_store_dwordx2 v[208:209], v222, s[72:75], s44 offen
    v_mfma_f32_16x16x32_bf16 v[132:135], a[252:255], a[24:27], v[132:135]
    buffer_load_dwordx4 v243, s[16:19], s49 offen offset:3840 lds
    v_mfma_f32_16x16x32_bf16 v[140:143], a[252:255], a[40:43], v[140:143]
    v_mfma_f32_16x16x32_bf16 v[148:151], a[252:255], a[56:59], v[148:151]
    v_mfma_f32_16x16x32_bf16 v[156:159], a[252:255], a[72:75], v[156:159]
    s_waitcnt vmcnt(29)
    s_waitcnt lgkmcnt(0)
    s_barrier
    s_lshl_b32 s56, s31, 8
    s_sub_u32 s56, s56, 512
    s_cselect_b32 s56, 0, s56
    s_cbranch_scc1 L_T_no
    v_mov_b32 v248, v241
    v_mov_b32 v222, v223
L_T_no:
    s_add_u32 s43, s48, 33792
    s_add_u32 s46, s47, 0
    s_add_u32 s49, s46, 5120
    v_mfma_f32_16x16x32_bf16 v[120:123], a[240:243], a[12:15], v[120:123]
    ds_read_b64_tr_b16 a[248:249], v255 offset:0
    ds_read_b64_tr_b16 a[250:251], v255 offset:256
    v_mfma_f32_16x16x32_bf16 v[128:131], a[240:243], a[28:31], v[128:131]
    ds_read_b64_tr_b16 a[252:253], v255 offset:32
    ds_read_b64_tr_b16 a[254:255], v255 offset:288
    v_mfma_f32_16x16x32_bf16 v[136:139], a[240:243], a[44:47], v[136:139]
    s_add_u32 m0, s43, 0
    v_mfma_f32_16x16x32_bf16 v[144:147], a[240:243], a[60:63], v[144:147]
    v_mfma_f32_16x16x32_bf16 v[152:155], a[240:243], a[76:79], v[152:155]
    buffer_load_dwordx4 v244, s[16:19], s46 offen offset:0 lds
    v_mfma_f32_16x16x32_bf16 v[124:127], a[244:247], a[12:15], v[124:127]
    ds_read_b64_tr_b16 a[240:241], v255 offset:8448
    v_mfma_f32_16x16x32_bf16 v[132:135], a[244:247], a[28:31], v[132:135]
    ds_read_b64_tr_b16 a[242:243], v255 offset:8704
    v_mfma_f32_16x16x32_bf16 v[140:143], a[244:247], a[44:47], v[140:143]
    s_add_u32 m0, s43, 1056
    v_mfma_f32_16x16x32_bf16 v[148:151], a[244:247], a[60:63], v[148:151]
    v_mfma_f32_16x16x32_bf16 v[156:159], a[244:247], a[76:79], v[156:159]
    s_waitcnt lgkmcnt(4)
    v_mfma_f32_16x16x32_bf16 v[80:83], a[248:251], a[80:83], v[80:83]
    ds_read_b64_tr_b16 a[244:245], v255 offset:8480
    v_mfma_f32_16x16x32_bf16 v[88:91], a[248:251], a[96:99], v[88:91]
    ds_read_b64_tr_b16 a[246:247], v255 offset:8736
    v_mfma_f32_16x16x32_bf16 v[96:99], a[248:251], a[112:115], v[96:99]
    buffer_load_dwordx4 v244, s[16:19], s49 offen offset:0 lds
    v_mfma_f32_16x16x32_bf16 v[104:107], a[248:251], a[128:131], v[104:107]
    s_add_u32 m0, s43, 832
    v_mfma_f32_16x16x32_bf16 v[112:115], a[248:251], a[144:147], v[112:115]
    s_waitcnt lgkmcnt(4)
    v_mfma_f32_16x16x32_bf16 v[84:87], a[252:255], a[80:83], v[84:87]
    ds_read_b64_tr_b16 a[248:249], v255 offset:16896
    v_mfma_f32_16x16x32_bf16 v[92:95], a[252:255], a[96:99], v[92:95]
    ds_read_b64_tr_b16 a[250:251], v255 offset:17152
    v_mfma_f32_16x16x32_bf16 v[100:103], a[252:255], a[112:115], v[100:103]
    v_mfma_f32_16x16x32_bf16 v[108:111], a[252:255], a[128:131], v[108:111]
    buffer_load_dwordx4 v244, s[16:19], s46 offen offset:1280 lds
    v_mfma_f32_16x16x32_bf16 v[116:119], a[252:255], a[144:147], v[116:119]
    s_waitcnt lgkmcnt(2)
    v_mfma_f32_16x16x32_bf16 v[80:83], a[240:243], a[84:87], v[80:83]
    ds_read_b64_tr_b16 a[252:253], v255 offset:16928
    v_mfma_f32_16x16x32_bf16 v[88:91], a[240:243], a[100:103], v[88:91]
    ds_read_b64_tr_b16 a[254:255], v255 offset:17184
    v_mfma_f32_16x16x32_bf16 v[96:99], a[240:243], a[116:119], v[96:99]
    s_add_u32 m0, s43, 1888
    v_mfma_f32_16x16x32_bf16 v[104:107], a[240:243], a[132:135], v[104:107]
    v_mfma_f32_16x16x32_bf16 v[112:115], a[240:243], a[148:151], v[112:115]
    buffer_load_dwordx4 v244, s[16:19], s49 offen offset:1280 lds
    v_mfma_f32_16x16x32_bf16 v[84:87], a[244:247], a[84:87], v[84:87]
    ds_read_b64_tr_b16 a[240:241], v255 offset:25344
    v_mfma_f32_16x16x32_bf16 v[92:95], a[244:247], a[100:103], v[92:95]
    ds_read_b64_tr_b16 a[242:243], v255 offset:25600
    v_mfma_f32_16x16x32_bf16 v[100:103], a[244:247], a[116:119], v[100:103]
    s_add_u32 m0, s43, 1664
    v_mfma_f32_16x16x32_bf16 v[108:111], a[244:247], a[132:135], v[108:111]
    v_mfma_f32_16x16x32_bf16 v[116:119], a[244:247], a[148:151], v[116:119]
    s_waitcnt lgkmcnt(2)
    v_mfma_f32_16x16x32_bf16 v[80:83], a[248:251], a[88:91], v[80:83]
    ds_read_b64_tr_b16 a[244:245], v255 offset:25376
    v_mfma_f32_16x16x32_bf16 v[88:91], a[248:251], a[104:107], v[88:91]
    ds_read_b64_tr_b16 a[246:247], v255 offset:25632
    v_mfma_f32_16x16x32_bf16 v[96:99], a[248:251], a[120:123], v[96:99]
    buffer_load_dwordx4 v244, s[16:19], s46 offen offset:2560 lds
    v_mfma_f32_16x16x32_bf16 v[104:107], a[248:251], a[136:139], v[104:107]
    v_mfma_f32_16x16x32_bf16 v[112:115], a[248:251], a[152:155], v[112:115]
    s_add_u32 m0, s43, 2720
    v_mfma_f32_16x16x32_bf16 v[84:87], a[252:255], a[88:91], v[84:87]
    ds_read_b64_tr_b16 a[248:249], v255 offset:64
    v_mfma_f32_16x16x32_bf16 v[92:95], a[252:255], a[104:107], v[92:95]
    ds_read_b64_tr_b16 a[250:251], v255 offset:320
    v_mfma_f32_16x16x32_bf16 v[100:103], a[252:255], a[120:123], v[100:103]
    buffer_load_dwordx4 v244, s[16:19], s49 offen offset:2560 lds
    v_mfma_f32_16x16x32_bf16 v[108:111], a[252:255], a[136:139], v[108:111]
    v_mfma_f32_16x16x32_bf16 v[116:119], a[252:255], a[152:155], v[116:119]
    s_waitcnt lgkmcnt(2)
    v_mfma_f32_16x16x32_bf16 v[80:83], a[240:243], a[92:95], v[80:83]
    ds_read_b64_tr_b16 a[252:253], v255 offset:96
    v_mfma_f32_16x16x32_bf16 v[88:91], a[240:243], a[108:111], v[88:91]
    ds_read_b64_tr_b16 a[254:255], v255 offset:352
    v_mfma_f32_16x16x32_bf16 v[96:99], a[240:243], a[124:127], v[96:99]
    s_add_u32 m0, s43, 2496
    v_mfma_f32_16x16x32_bf16 v[104:107], a[240:243], a[140:143], v[104:107]
    buffer_load_dwordx4 v244, s[16:19], s46 offen offset:3840 lds
    v_mfma_f32_16x16x32_bf16 v[112:115], a[240:243], a[156:159], v[112:115]
    v_mfma_f32_16x16x32_bf16 v[84:87], a[244:247], a[92:95], v[84:87]
    ds_read_b64_tr_b16 a[240:241], v255 offset:8512
    v_mfma_f32_16x16x32_bf16 v[92:95], a[244:247], a[108:111], v[92:95]
    ds_read_b64_tr_b16 a[242:243], v255 offset:8768
    v_mfma_f32_16x16x32_bf16 v[100:103], a[244:247], a[124:127], v[100:103]
    s_add_u32 m0, s43, 3552
    v_mfma_f32_16x16x32_bf16 v[108:111], a[244:247], a[140:143], v[108:111]
    buffer_load_dwordx4 v244, s[16:19], s49 offen offset:3840 lds
    v_mfma_f32_16x16x32_bf16 v[116:119], a[244:247], a[156:159], v[116:119]
    s_waitcnt lgkmcnt(2)
    v_mfma_f32_16x16x32_bf16 v[120:123], a[248:251], a[80:83], v[120:123]
    ds_read_b64_tr_b16 a[244:245], v255 offset:8544
    v_mfma_f32_16x16x32_bf16 v[128:131], a[248:251], a[96:99], v[128:131]
    ds_read_b64_tr_b16 a[246:247], v255 offset:8800
    v_mfma_f32_16x16x32_bf16 v[136:139], a[248:251], a[112:115], v[136:139]
    v_mfma_f32_16x16x32_bf16 v[144:147], a[248:251], a[128:131], v[144:147]
    v_cvt_pk_bf16_f32 v232, v80, v81
    v_mfma_f32_16x16x32_bf16 v[152:155], a[248:251], a[144:147], v[152:155]
    v_cvt_pk_bf16_f32 v233, v82, v83
    v_cvt_pk_bf16_f32 v234, v84, v85
    v_mfma_f32_16x16x32_bf16 v[124:127], a[252:255], a[80:83], v[124:127]
    ds_read_b64_tr_b16 a[248:249], v255 offset:16960
    v_mfma_f32_16x16x32_bf16 v[132:135], a[252:255], a[96:99], v[132:135]
    ds_read_b64_tr_b16 a[250:251], v255 offset:17216
    v_mfma_f32_16x16x32_bf16 v[140:143], a[252:255], a[112:115], v[140:143]
    s_add_u32 s45, s58, 0
    v_cvt_pk_bf16_f32 v235, v86, v87
    v_mfma_f32_16x16x32_bf16 v[148:151], a[252:255], a[128:131], v[148:151]
    buffer_store_dwordx4 v[232:235], v245, s[24:27], s45 offen offset:0 sc1
    v_cvt_pk_bf16_f32 v236, v88, v89
    v_mfma_f32_16x16x32_bf16 v[156:159], a[252:255], a[144:147], v[156:159]
    s_waitcnt lgkmcnt(2)
    v_mfma_f32_16x16x32_bf16 v[120:123], a[240:243], a[84:87], v[120:123]
    ds_read_b64_tr_b16 a[252:253], v255 offset:16992
    v_cvt_pk_bf16_f32 v237, v90, v91
    v_mfma_f32_16x16x32_bf16 v[128:131], a[240:243], a[100:103], v[128:131]
    ds_read_b64_tr_b16 a[254:255], v255 offset:17248
    v_mfma_f32_16x16x32_bf16 v[136:139], a[240:243], a[116:119], v[136:139]
    v_cvt_pk_bf16_f32 v238, v92, v93
    v_mfma_f32_16x16x32_bf16 v[144:147], a[240:243], a[132:135], v[144:147]
    s_add_u32 s45, s58, 4096
    v_cvt_pk_bf16_f32 v239, v94, v95
    v_mfma_f32_16x16x32_bf16 v[152:155], a[240:243], a[148:151], v[152:155]
    buffer_store_dwordx4 v[236:239], v245, s[24:27], s45 offen offset:0 sc1
    v_cvt_pk_bf16_f32 v232, v96, v97
    v_mfma_f32_16x16x32_bf16 v[124:127], a[244:247], a[84:87], v[124:127]
    ds_read_b64_tr_b16 a[240:241], v255 offset:25408
    v_mfma_f32_16x16x32_bf16 v[132:135], a[244:247], a[100:103], v[132:135]
    ds_read_b64_tr_b16 a[242:243], v255 offset:25664
    v_mfma_f32_16x16x32_bf16 v[140:143], a[244:247], a[116:119], v[140:143]
    v_cvt_pk_bf16_f32 v233, v98, v99
    v_cvt_pk_bf16_f32 v234, v100, v101
    v_mfma_f32_16x16x32_bf16 v[148:151], a[244:247], a[132:135], v[148:151]
    v_cvt_pk_bf16_f32 v235, v102, v103
    v_mfma_f32_16x16x32_bf16 v[156:159], a[244:247], a[148:151], v[156:159]
    s_add_u32 s45, s58, 8192
    s_waitcnt lgkmcnt(2)
    v_mfma_f32_16x16x32_bf16 v[120:123], a[248:251], a[88:91], v[120:123]
    ds_read_b64_tr_b16 a[244:245], v255 offset:25440
    v_mfma_f32_16x16x32_bf16 v[128:131], a[248:251], a[104:107], v[128:131]
    ds_read_b64_tr_b16 a[246:247], v255 offset:25696
    buffer_store_dwordx4 v[232:235], v245, s[24:27], s45 offen offset:0 sc1
    v_mfma_f32_16x16x32_bf16 v[136:139], a[248:251], a[120:123], v[136:139]
    v_cvt_pk_bf16_f32 v236, v104, v105
    v_mfma_f32_16x16x32_bf16 v[144:147], a[248:251], a[136:139], v[144:147]
    v_cvt_pk_bf16_f32 v237, v106, v107
    v_cvt_pk_bf16_f32 v238, v108, v109
    v_mfma_f32_16x16x32_bf16 v[152:155], a[248:251], a[152:155], v[152:155]
    v_cvt_pk_bf16_f32 v239, v110, v111
    v_mfma_f32_16x16x32_bf16 v[124:127], a[252:255], a[88:91], v[124:127]
    s_add_u32 s45, s58, 12288
    buffer_store_dwordx4 v[236:239], v245, s[24:27], s45 offen offset:0 sc1
    v_mfma_f32_16x16x32_bf16 v[132:135], a[252:255], a[104:107], v[132:135]
    v_cvt_pk_bf16_f32 v232, v112, v113
    v_mfma_f32_16x16x32_bf16 v[140:143], a[252:255], a[120:123], v[140:143]
    v_cvt_pk_bf16_f32 v233, v114, v115
    v_cvt_pk_bf16_f32 v234, v116, v117
    v_mfma_f32_16x16x32_bf16 v[148:151], a[252:255], a[136:139], v[148:151]
    v_cvt_pk_bf16_f32 v235, v118, v119
    v_mfma_f32_16x16x32_bf16 v[156:159], a[252:255], a[152:155], v[156:159]
    s_add_u32 s45, s58, 16384
    buffer_store_dwordx4 v[232:235], v245, s[24:27], s45 offen offset:0 sc1
    s_waitcnt vmcnt(34)
    s_add_u32 s31, s31, 1
    s_cmp_lt_u32 s31, 5
    s_waitcnt lgkmcnt(0)
    s_barrier
    s_cbranch_scc1 L_T_loop
    v_mfma_f32_16x16x32_bf16 v[120:123], a[240:243], a[92:95], v[120:123]
    v_mfma_f32_16x16x32_bf16 v[128:131], a[240:243], a[108:111], v[128:131]
    v_mfma_f32_16x16x32_bf16 v[136:139], a[240:243], a[124:127], v[136:139]
    v_mfma_f32_16x16x32_bf16 v[144:147], a[240:243], a[140:143], v[144:147]
    v_mfma_f32_16x16x32_bf16 v[152:155], a[240:243], a[156:159], v[152:155]
    v_mfma_f32_16x16x32_bf16 v[124:127], a[244:247], a[92:95], v[124:127]
    v_mfma_f32_16x16x32_bf16 v[132:135], a[244:247], a[108:111], v[132:135]
    v_mfma_f32_16x16x32_bf16 v[140:143], a[244:247], a[124:127], v[140:143]
    v_mfma_f32_16x16x32_bf16 v[148:151], a[244:247], a[140:143], v[148:151]
    v_mfma_f32_16x16x32_bf16 v[156:159], a[244:247], a[156:159], v[156:159]
    s_movk_i32 s59, 384
    buffer_load_dword v250, v249, s[68:71], s59 offen sc1
    v_cvt_pk_bf16_f32 v232, v120, v121
    v_cvt_pk_bf16_f32 v233, v122, v123
    v_cvt_pk_bf16_f32 v234, v124, v125
    v_cvt_pk_bf16_f32 v235, v126, v127
    s_add_u32 s45, s58, 0
    buffer_store_dwordx4 v[232:235], v245, s[24:27], s45 offen offset:1024 sc1
    v_cvt_pk_bf16_f32 v236, v128, v129
    v_cvt_pk_bf16_f32 v237, v130, v131
    v_cvt_pk_bf16_f32 v238, v132, v133
    v_cvt_pk_bf16_f32 v239, v134, v135
    s_add_u32 s45, s58, 4096
    buffer_store_dwordx4 v[236:239], v245, s[24:27], s45 offen offset:1024 sc1
    v_cvt_pk_bf16_f32 v232, v136, v137
    v_cvt_pk_bf16_f32 v233, v138, v139
    v_cvt_pk_bf16_f32 v234, v140, v141
    v_cvt_pk_bf16_f32 v235, v142, v143
    s_add_u32 s45, s58, 8192
    buffer_store_dwordx4 v[232:235], v245, s[24:27], s45 offen offset:1024 sc1
    v_cvt_pk_bf16_f32 v236, v144, v145
    v_cvt_pk_bf16_f32 v237, v146, v147
    v_cvt_pk_bf16_f32 v238, v148, v149
    v_cvt_pk_bf16_f32 v239, v150, v151
    s_add_u32 s45, s58, 12288
    buffer_store_dwordx4 v[236:239], v245, s[24:27], s45 offen offset:1024 sc1
    v_cvt_pk_bf16_f32 v232, v152, v153
    v_cvt_pk_bf16_f32 v233, v154, v155
    v_cvt_pk_bf16_f32 v234, v156, v157
    v_cvt_pk_bf16_f32 v235, v158, v159
    s_add_u32 s45, s58, 16384
    buffer_store_dwordx4 v[232:235], v245, s[24:27], s45 offen offset:1024 sc1
    s_waitcnt vmcnt(5)
    s_call_b64 s[50:51], S_reda
    s_waitcnt vmcnt(3)
    s_barrier
    s_movk_i32 s44, 512
    s_call_b64 s[50:51], S_post
    s_call_b64 s[50:51], S_spinc
    s_mov_b32 s55, 122880
    s_movk_i32 s56, 768
    s_call_b64 s[50:51], S_ld
    s_movk_i32 s59, 512
    s_call_b64 s[50:51], S_spin
    s_mov_b32 s55, 163840
    s_movk_i32 s56, 1024
    s_call_b64 s[50:51], S_ld
L_exit:
    s_endpgm
S_rare0:
    v_max3_f32 v232, v80, v81, v82
    v_max3_f32 v232, v232, v83, v84
    v_max3_f32 v232, v232, v85, v86
    v_max_f32 v232, v232, v87
    v_mov_b32 v233, v232
    s_nop 1
    v_permlane16_swap_b32 v232, v233
    v_max_f32 v232, v232, v233
    v_mov_b32 v233, v232
    s_nop 1
    v_permlane32_swap_b32 v232, v233
    v_max_f32 v232, v232, v233
    v_max_f32 v232, 0, v232
    v_exp_f32 v218, -v232
    v_sub_f32 v80, v80, v232
    v_sub_f32 v81, v81, v232
    v_sub_f32 v82, v82, v232
    v_sub_f32 v83, v83, v232
    v_sub_f32 v84, v84, v232
    v_sub_f32 v85, v85, v232
    v_sub_f32 v86, v86, v232
    v_sub_f32 v87, v87, v232
    v_sub_f32 v160, v160, v232
    v_sub_f32 v161, v161, v232
    v_sub_f32 v162, v162, v232
    v_sub_f32 v163, v163, v232
    v_max3_f32 v232, v88, v89, v90
    v_max3_f32 v232, v232, v91, v92
    v_max3_f32 v232, v232, v93, v94
    v_max_f32 v232, v232, v95
    v_mov_b32 v233, v232
    s_nop 1
    v_permlane16_swap_b32 v232, v233
    v_max_f32 v232, v232, v233
    v_mov_b32 v233, v232
    s_nop 1
    v_permlane32_swap_b32 v232, v233
    v_max_f32 v232, v232, v233
    v_max_f32 v232, 0, v232
    v_exp_f32 v220, -v232
    v_sub_f32 v88, v88, v232
    v_sub_f32 v89, v89, v232
    v_sub_f32 v90, v90, v232
    v_sub_f32 v91, v91, v232
    v_sub_f32 v92, v92, v232
    v_sub_f32 v93, v93, v232
    v_sub_f32 v94, v94, v232
    v_sub_f32 v95, v95, v232
    v_sub_f32 v164, v164, v232
    v_sub_f32 v165, v165, v232
    v_sub_f32 v166, v166, v232
    v_sub_f32 v167, v167, v232
    v_max3_f32 v232, v96, v97, v98
    v_max3_f32 v232, v232, v99, v100
    v_max3_f32 v232, v232, v101, v102
    v_max_f32 v232, v232, v103
    v_mov_b32 v233, v232
    s_nop 1
    v_permlane16_swap_b32 v232, v233
    v_max_f32 v232, v232, v233
    v_mov_b32 v233, v232
    s_nop 1
    v_permlane32_swap_b32 v232, v233
    v_max_f32 v232, v232, v233
    v_max_f32 v232, 0, v232
    v_exp_f32 v246, -v232
    v_sub_f32 v96, v96, v232
    v_sub_f32 v97, v97, v232
    v_sub_f32 v98, v98, v232
    v_sub_f32 v99, v99, v232
    v_sub_f32 v100, v100, v232
    v_sub_f32 v101, v101, v232
    v_sub_f32 v102, v102, v232
    v_sub_f32 v103, v103, v232
    v_sub_f32 v168, v168, v232
    v_sub_f32 v169, v169, v232
    v_sub_f32 v170, v170, v232
    v_sub_f32 v171, v171, v232
    v_max3_f32 v232, v104, v105, v106
    v_max3_f32 v232, v232, v107, v108
    v_max3_f32 v232, v232, v109, v110
    v_max_f32 v232, v232, v111
    v_mov_b32 v233, v232
    s_nop 1
    v_permlane16_swap_b32 v232, v233
    v_max_f32 v232, v232, v233
    v_mov_b32 v233, v232
    s_nop 1
    v_permlane32_swap_b32 v232, v233
    v_max_f32 v232, v232, v233
    v_max_f32 v232, 0, v232
    v_exp_f32 v248, -v232
    v_sub_f32 v104, v104, v232
    v_sub_f32 v105, v105, v232
    v_sub_f32 v106, v106, v232
    v_sub_f32 v107, v107, v232
    v_sub_f32 v108, v108, v232
    v_sub_f32 v109, v109, v232
    v_sub_f32 v110, v110, v232
    v_sub_f32 v111, v111, v232
    v_sub_f32 v172, v172, v232
    v_sub_f32 v173, v173, v232
    v_sub_f32 v174, v174, v232
    v_sub_f32 v175, v175, v232
    v_max3_f32 v232, v112, v113, v114
    v_max3_f32 v232, v232, v115, v116
    v_max3_f32 v232, v232, v117, v118
    v_max_f32 v232, v232, v119
    v_mov_b32 v233, v232
    s_nop 1
    v_permlane16_swap_b32 v232, v233
    v_max_f32 v232, v232, v233
    v_mov_b32 v233, v232
    s_nop 1
    v_permlane32_swap_b32 v232, v233
    v_max_f32 v232, v232, v233
    v_max_f32 v232, 0, v232
    v_exp_f32 v250, -v232
    v_sub_f32 v112, v112, v232
    v_sub_f32 v113, v113, v232
    v_sub_f32 v114, v114, v232
    v_sub_f32 v115, v115, v232
    v_sub_f32 v116, v116, v232
    v_sub_f32 v117, v117, v232
    v_sub_f32 v118, v118, v232
    v_sub_f32 v119, v119, v232
    v_sub_f32 v176, v176, v232
    v_sub_f32 v177, v177, v232
    v_sub_f32 v178, v178, v232
    v_sub_f32 v179, v179, v232
    s_setpc_b64 s[50:51]
S_rare1:
    v_max3_f32 v232, v120, v121, v122
    v_max3_f32 v232, v232, v123, v124
    v_max3_f32 v232, v232, v125, v126
    v_max_f32 v232, v232, v127
    v_mov_b32 v233, v232
    s_nop 1
    v_permlane16_swap_b32 v232, v233
    v_max_f32 v232, v232, v233
    v_mov_b32 v233, v232
    s_nop 1
    v_permlane32_swap_b32 v232, v233
    v_max_f32 v232, v232, v233
    v_max_f32 v232, 0, v232
    v_exp_f32 v218, -v232
    v_sub_f32 v120, v120, v232
    v_sub_f32 v121, v121, v232
    v_sub_f32 v122, v122, v232
    v_sub_f32 v123, v123, v232
    v_sub_f32 v124, v124, v232
    v_sub_f32 v125, v125, v232
    v_sub_f32 v126, v126, v232
    v_sub_f32 v127, v127, v232
    v_sub_f32 v160, v160, v232
    v_sub_f32 v161, v161, v232
    v_sub_f32 v162, v162, v232
    v_sub_f32 v163, v163, v232
    v_max3_f32 v232, v128, v129, v130
    v_max3_f32 v232, v232, v131, v132
    v_max3_f32 v232, v232, v133, v134
    v_max_f32 v232, v232, v135
    v_mov_b32 v233, v232
    s_nop 1
    v_permlane16_swap_b32 v232, v233
    v_max_f32 v232, v232, v233
    v_mov_b32 v233, v232
    s_nop 1
    v_permlane32_swap_b32 v232, v233
    v_max_f32 v232, v232, v233
    v_max_f32 v232, 0, v232
    v_exp_f32 v220, -v232
    v_sub_f32 v128, v128, v232
    v_sub_f32 v129, v129, v232
    v_sub_f32 v130, v130, v232
    v_sub_f32 v131, v131, v232
    v_sub_f32 v132, v132, v232
    v_sub_f32 v133, v133, v232
    v_sub_f32 v134, v134, v232
    v_sub_f32 v135, v135, v232
    v_sub_f32 v164, v164, v232
    v_sub_f32 v165, v165, v232
    v_sub_f32 v166, v166, v232
    v_sub_f32 v167, v167, v232
    v_max3_f32 v232, v136, v137, v138
    v_max3_f32 v232, v232, v139, v140
    v_max3_f32 v232, v232, v141, v142
    v_max_f32 v232, v232, v143
    v_mov_b32 v233, v232
    s_nop 1
    v_permlane16_swap_b32 v232, v233
    v_max_f32 v232, v232, v233
    v_mov_b32 v233, v232
    s_nop 1
    v_permlane32_swap_b32 v232, v233
    v_max_f32 v232, v232, v233
    v_max_f32 v232, 0, v232
    v_exp_f32 v246, -v232
    v_sub_f32 v136, v136, v232
    v_sub_f32 v137, v137, v232
    v_sub_f32 v138, v138, v232
    v_sub_f32 v139, v139, v232
    v_sub_f32 v140, v140, v232
    v_sub_f32 v141, v141, v232
    v_sub_f32 v142, v142, v232
    v_sub_f32 v143, v143, v232
    v_sub_f32 v168, v168, v232
    v_sub_f32 v169, v169, v232
    v_sub_f32 v170, v170, v232
    v_sub_f32 v171, v171, v232
    v_max3_f32 v232, v144, v145, v146
    v_max3_f32 v232, v232, v147, v148
    v_max3_f32 v232, v232, v149, v150
    v_max_f32 v232, v232, v151
    v_mov_b32 v233, v232
    s_nop 1
    v_permlane16_swap_b32 v232, v233
    v_max_f32 v232, v232, v233
    v_mov_b32 v233, v232
    s_nop 1
    v_permlane32_swap_b32 v232, v233
    v_max_f32 v232, v232, v233
    v_max_f32 v232, 0, v232
    v_exp_f32 v248, -v232
    v_sub_f32 v144, v144, v232
    v_sub_f32 v145, v145, v232
    v_sub_f32 v146, v146, v232
    v_sub_f32 v147, v147, v232
    v_sub_f32 v148, v148, v232
    v_sub_f32 v149, v149, v232
    v_sub_f32 v150, v150, v232
    v_sub_f32 v151, v151, v232
    v_sub_f32 v172, v172, v232
    v_sub_f32 v173, v173, v232
    v_sub_f32 v174, v174, v232
    v_sub_f32 v175, v175, v232
    v_max3_f32 v232, v152, v153, v154
    v_max3_f32 v232, v232, v155, v156
    v_max3_f32 v232, v232, v157, v158
    v_max_f32 v232, v232, v159
    v_mov_b32 v233, v232
    s_nop 1
    v_permlane16_swap_b32 v232, v233
    v_max_f32 v232, v232, v233
    v_mov_b32 v233, v232
    s_nop 1
    v_permlane32_swap_b32 v232, v233
    v_max_f32 v232, v232, v233
    v_max_f32 v232, 0, v232
    v_exp_f32 v250, -v232
    v_sub_f32 v152, v152, v232
    v_sub_f32 v153, v153, v232
    v_sub_f32 v154, v154, v232
    v_sub_f32 v155, v155, v232
    v_sub_f32 v156, v156, v232
    v_sub_f32 v157, v157, v232
    v_sub_f32 v158, v158, v232
    v_sub_f32 v159, v159, v232
    v_sub_f32 v176, v176, v232
    v_sub_f32 v177, v177, v232
    v_sub_f32 v178, v178, v232
    v_sub_f32 v179, v179, v232
    s_setpc_b64 s[50:51]
S_first:
    v_max3_f32 v232, v80, v81, v82
    s_nop 1
    v_max3_f32 v232, v232, v83, v84
    v_max3_f32 v232, v232, v85, v86
    v_max_f32 v232, v232, v87
    v_mov_b32 v233, v232
    s_nop 1
    v_permlane16_swap_b32 v232, v233
    v_max_f32 v232, v232, v233
    v_mov_b32 v233, v232
    s_nop 1
    v_permlane32_swap_b32 v232, v233
    v_max_f32 v232, v232, v233
    v_sub_f32 v80, v80, v232
    v_sub_f32 v81, v81, v232
    v_sub_f32 v82, v82, v232
    v_sub_f32 v83, v83, v232
    v_sub_f32 v84, v84, v232
    v_sub_f32 v85, v85, v232
    v_sub_f32 v86, v86, v232
    v_sub_f32 v87, v87, v232
    v_sub_f32 v160, v160, v232
    v_sub_f32 v161, v161, v232
    v_sub_f32 v162, v162, v232
    v_sub_f32 v163, v163, v232
    v_max3_f32 v232, v88, v89, v90
    v_max3_f32 v232, v232, v91, v92
    v_max3_f32 v232, v232, v93, v94
    v_max_f32 v232, v232, v95
    v_mov_b32 v233, v232
    s_nop 1
    v_permlane16_swap_b32 v232, v233
    v_max_f32 v232, v232, v233
    v_mov_b32 v233, v232
    s_nop 1
    v_permlane32_swap_b32 v232, v233
    v_max_f32 v232, v232, v233
    v_sub_f32 v88, v88, v232
    v_sub_f32 v89, v89, v232
    v_sub_f32 v90, v90, v232
    v_sub_f32 v91, v91, v232
    v_sub_f32 v92, v92, v232
    v_sub_f32 v93, v93, v232
    v_sub_f32 v94, v94, v232
    v_sub_f32 v95, v95, v232
    v_sub_f32 v164, v164, v232
    v_sub_f32 v165, v165, v232
    v_sub_f32 v166, v166, v232
    v_sub_f32 v167, v167, v232
    v_max3_f32 v232, v96, v97, v98
    v_max3_f32 v232, v232, v99, v100
    v_max3_f32 v232, v232, v101, v102
    v_max_f32 v232, v232, v103
    v_mov_b32 v233, v232
    s_nop 1
    v_permlane16_swap_b32 v232, v233
    v_max_f32 v232, v232, v233
    v_mov_b32 v233, v232
    s_nop 1
    v_permlane32_swap_b32 v232, v233
    v_max_f32 v232, v232, v233
    v_sub_f32 v96, v96, v232
    v_sub_f32 v97, v97, v232
    v_sub_f32 v98, v98, v232
    v_sub_f32 v99, v99, v232
    v_sub_f32 v100, v100, v232
    v_sub_f32 v101, v101, v232
    v_sub_f32 v102, v102, v232
    v_sub_f32 v103, v103, v232
    v_sub_f32 v168, v168, v232
    v_sub_f32 v169, v169, v232
    v_sub_f32 v170, v170, v232
    v_sub_f32 v171, v171, v232
    v_max3_f32 v232, v104, v105, v106
    v_max3_f32 v232, v232, v107, v108
    v_max3_f32 v232, v232, v109, v110
    v_max_f32 v232, v232, v111
    v_mov_b32 v233, v232
    s_nop 1
    v_permlane16_swap_b32 v232, v233
    v_max_f32 v232, v232, v233
    v_mov_b32 v233, v232
    s_nop 1
    v_permlane32_swap_b32 v232, v233
    v_max_f32 v232, v232, v233
    v_sub_f32 v104, v104, v232
    v_sub_f32 v105, v105, v232
    v_sub_f32 v106, v106, v232
    v_sub_f32 v107, v107, v232
    v_sub_f32 v108, v108, v232
    v_sub_f32 v109, v109, v232
    v_sub_f32 v110, v110, v232
    v_sub_f32 v111, v111, v232
    v_sub_f32 v172, v172, v232
    v_sub_f32 v173, v173, v232
    v_sub_f32 v174, v174, v232
    v_sub_f32 v175, v175, v232
    v_max3_f32 v232, v112, v113, v114
    v_max3_f32 v232, v232, v115, v116
    v_max3_f32 v232, v232, v117, v118
    v_max_f32 v232, v232, v119
    v_mov_b32 v233, v232
    s_nop 1
    v_permlane16_swap_b32 v232, v233
    v_max_f32 v232, v232, v233
    v_mov_b32 v233, v232
    s_nop 1
    v_permlane32_swap_b32 v232, v233
    v_max_f32 v232, v232, v233
    v_sub_f32 v112, v112, v232
    v_sub_f32 v113, v113, v232
    v_sub_f32 v114, v114, v232
    v_sub_f32 v115, v115, v232
    v_sub_f32 v116, v116, v232
    v_sub_f32 v117, v117, v232
    v_sub_f32 v118, v118, v232
    v_sub_f32 v119, v119, v232
    v_sub_f32 v176, v176, v232
    v_sub_f32 v177, v177, v232
    v_sub_f32 v178, v178, v232
    v_sub_f32 v179, v179, v232
    s_setpc_b64 s[50:51]
S_scale:
    v_accvgpr_read_b32 v236, a0
    v_accvgpr_read_b32 v237, a1
    v_accvgpr_read_b32 v238, a2
    v_accvgpr_read_b32 v239, a3
    v_pk_mul_f32 v[236:237], v[236:237], v[218:219] op_sel_hi:[1,0]
    v_pk_mul_f32 v[238:239], v[238:239], v[218:219] op_sel_hi:[1,0]
    v_accvgpr_write_b32 a0, v236
    v_accvgpr_write_b32 a1, v237
    v_accvgpr_write_b32 a2, v238
    v_accvgpr_write_b32 a3, v239
    v_accvgpr_read_b32 v236, a4
    v_accvgpr_read_b32 v237, a5
    v_accvgpr_read_b32 v238, a6
    v_accvgpr_read_b32 v239, a7
    v_pk_mul_f32 v[236:237], v[236:237], v[220:221] op_sel_hi:[1,0]
    v_pk_mul_f32 v[238:239], v[238:239], v[220:221] op_sel_hi:[1,0]
    v_accvgpr_write_b32 a4, v236
    v_accvgpr_write_b32 a5, v237
    v_accvgpr_write_b32 a6, v238
    v_accvgpr_write_b32 a7, v239
    v_accvgpr_read_b32 v236, a8
    v_accvgpr_read_b32 v237, a9
    v_accvgpr_read_b32 v238, a10
    v_accvgpr_read_b32 v239, a11
    v_pk_mul_f32 v[236:237], v[236:237], v[246:247] op_sel_hi:[1,0]
    v_pk_mul_f32 v[238:239], v[238:239], v[246:247] op_sel_hi:[1,0]
    v_accvgpr_write_b32 a8, v236
    v_accvgpr_write_b32 a9, v237
    v_accvgpr_write_b32 a10, v238
    v_accvgpr_write_b32 a11, v239
    v_accvgpr_read_b32 v236, a12
    v_accvgpr_read_b32 v237, a13
    v_accvgpr_read_b32 v238, a14
    v_accvgpr_read_b32 v239, a15
    v_pk_mul_f32 v[236:237], v[236:237], v[248:249] op_sel_hi:[1,0]
    v_pk_mul_f32 v[238:239], v[238:239], v[248:249] op_sel_hi:[1,0]
    v_accvgpr_write_b32 a12, v236
    v_accvgpr_write_b32 a13, v237
    v_accvgpr_write_b32 a14, v238
    v_accvgpr_write_b32 a15, v239
    v_accvgpr_read_b32 v236, a16
    v_accvgpr_read_b32 v237, a17
    v_accvgpr_read_b32 v238, a18
    v_accvgpr_read_b32 v239, a19
    v_pk_mul_f32 v[236:237], v[236:237], v[250:251] op_sel_hi:[1,0]
    v_pk_mul_f32 v[238:239], v[238:239], v[250:251] op_sel_hi:[1,0]
    v_accvgpr_write_b32 a16, v236
    v_accvgpr_write_b32 a17, v237
    v_accvgpr_write_b32 a18, v238
    v_accvgpr_write_b32 a19, v239
    v_accvgpr_read_b32 v236, a20
    v_accvgpr_read_b32 v237, a21
    v_accvgpr_read_b32 v238, a22
    v_accvgpr_read_b32 v239, a23
    v_pk_mul_f32 v[236:237], v[236:237], v[218:219] op_sel_hi:[1,0]
    v_pk_mul_f32 v[238:239], v[238:239], v[218:219] op_sel_hi:[1,0]
    v_accvgpr_write_b32 a20, v236
    v_accvgpr_write_b32 a21, v237
    v_accvgpr_write_b32 a22, v238
    v_accvgpr_write_b32 a23, v239
    v_accvgpr_read_b32 v236, a24
    v_accvgpr_read_b32 v237, a25
    v_accvgpr_read_b32 v238, a26
    v_accvgpr_read_b32 v239, a27
    v_pk_mul_f32 v[236:237], v[236:237], v[220:221] op_sel_hi:[1,0]
    v_pk_mul_f32 v[238:239], v[238:239], v[220:221] op_sel_hi:[1,0]
    v_accvgpr_write_b32 a24, v236
    v_accvgpr_write_b32 a25, v237
    v_accvgpr_write_b32 a26, v238
    v_accvgpr_write_b32 a27, v239
    v_accvgpr_read_b32 v236, a28
    v_accvgpr_read_b32 v237, a29
    v_accvgpr_read_b32 v238, a30
    v_accvgpr_read_b32 v239, a31
    v_pk_mul_f32 v[236:237], v[236:237], v[246:247] op_sel_hi:[1,0]
    v_pk_mul_f32 v[238:239], v[238:239], v[246:247] op_sel_hi:[1,0]
    v_accvgpr_write_b32 a28, v236
    v_accvgpr_write_b32 a29, v237
    v_accvgpr_write_b32 a30, v238
    v_accvgpr_write_b32 a31, v239
    v_accvgpr_read_b32 v236, a32
    v_accvgpr_read_b32 v237, a33
    v_accvgpr_read_b32 v238, a34
    v_accvgpr_read_b32 v239, a35
    v_pk_mul_f32 v[236:237], v[236:237], v[248:249] op_sel_hi:[1,0]
    v_pk_mul_f32 v[238:239], v[238:239], v[248:249] op_sel_hi:[1,0]
    v_accvgpr_write_b32 a32, v236
    v_accvgpr_write_b32 a33, v237
    v_accvgpr_write_b32 a34, v238
    v_accvgpr_write_b32 a35, v239
    v_accvgpr_read_b32 v236, a36
    v_accvgpr_read_b32 v237, a37
    v_accvgpr_read_b32 v238, a38
    v_accvgpr_read_b32 v239, a39
    v_pk_mul_f32 v[236:237], v[236:237], v[250:251] op_sel_hi:[1,0]
    v_pk_mul_f32 v[238:239], v[238:239], v[250:251] op_sel_hi:[1,0]
    v_accvgpr_write_b32 a36, v236
    v_accvgpr_write_b32 a37, v237
    v_accvgpr_write_b32 a38, v238
    v_accvgpr_write_b32 a39, v239
    v_accvgpr_read_b32 v236, a40
    v_accvgpr_read_b32 v237, a41
    v_accvgpr_read_b32 v238, a42
    v_accvgpr_read_b32 v239, a43
    v_pk_mul_f32 v[236:237], v[236:237], v[218:219] op_sel_hi:[1,0]
    v_pk_mul_f32 v[238:239], v[238:239], v[218:219] op_sel_hi:[1,0]
    v_accvgpr_write_b32 a40, v236
    v_accvgpr_write_b32 a41, v237
    v_accvgpr_write_b32 a42, v238
    v_accvgpr_write_b32 a43, v239
    v_accvgpr_read_b32 v236, a44
    v_accvgpr_read_b32 v237, a45
    v_accvgpr_read_b32 v238, a46
    v_accvgpr_read_b32 v239, a47
    v_pk_mul_f32 v[236:237], v[236:237], v[220:221] op_sel_hi:[1,0]
    v_pk_mul_f32 v[238:239], v[238:239], v[220:221] op_sel_hi:[1,0]
    v_accvgpr_write_b32 a44, v236
    v_accvgpr_write_b32 a45, v237
    v_accvgpr_write_b32 a46, v238
    v_accvgpr_write_b32 a47, v239
    v_accvgpr_read_b32 v236, a48
    v_accvgpr_read_b32 v237, a49
    v_accvgpr_read_b32 v238, a50
    v_accvgpr_read_b32 v239, a51
    v_pk_mul_f32 v[236:237], v[236:237], v[246:247] op_sel_hi:[1,0]
    v_pk_mul_f32 v[238:239], v[238:239], v[246:247] op_sel_hi:[1,0]
    v_accvgpr_write_b32 a48, v236
    v_accvgpr_write_b32 a49, v237
    v_accvgpr_write_b32 a50, v238
    v_accvgpr_write_b32 a51, v239
    v_accvgpr_read_b32 v236, a52
    v_accvgpr_read_b32 v237, a53
    v_accvgpr_read_b32 v238, a54
    v_accvgpr_read_b32 v239, a55
    v_pk_mul_f32 v[236:237], v[236:237], v[248:249] op_sel_hi:[1,0]
    v_pk_mul_f32 v[238:239], v[238:239], v[248:249] op_sel_hi:[1,0]
    v_accvgpr_write_b32 a52, v236
    v_accvgpr_write_b32 a53, v237
    v_accvgpr_write_b32 a54, v238
    v_accvgpr_write_b32 a55, v239
    v_accvgpr_read_b32 v236, a56
    v_accvgpr_read_b32 v237, a57
    v_accvgpr_read_b32 v238, a58
    v_accvgpr_read_b32 v239, a59
    v_pk_mul_f32 v[236:237], v[236:237], v[250:251] op_sel_hi:[1,0]
    v_pk_mul_f32 v[238:239], v[238:239], v[250:251] op_sel_hi:[1,0]
    v_accvgpr_write_b32 a56, v236
    v_accvgpr_write_b32 a57, v237
    v_accvgpr_write_b32 a58, v238
    v_accvgpr_write_b32 a59, v239
    v_accvgpr_read_b32 v236, a60
    v_accvgpr_read_b32 v237, a61
    v_accvgpr_read_b32 v238, a62
    v_accvgpr_read_b32 v239, a63
    v_pk_mul_f32 v[236:237], v[236:237], v[218:219] op_sel_hi:[1,0]
    v_pk_mul_f32 v[238:239], v[238:239], v[218:219] op_sel_hi:[1,0]
    v_accvgpr_write_b32 a60, v236
    v_accvgpr_write_b32 a61, v237
    v_accvgpr_write_b32 a62, v238
    v_accvgpr_write_b32 a63, v239
    v_accvgpr_read_b32 v236, a64
    v_accvgpr_read_b32 v237, a65
    v_accvgpr_read_b32 v238, a66
    v_accvgpr_read_b32 v239, a67
    v_pk_mul_f32 v[236:237], v[236:237], v[220:221] op_sel_hi:[1,0]
    v_pk_mul_f32 v[238:239], v[238:239], v[220:221] op_sel_hi:[1,0]
    v_accvgpr_write_b32 a64, v236
    v_accvgpr_write_b32 a65, v237
    v_accvgpr_write_b32 a66, v238
    v_accvgpr_write_b32 a67, v239
    v_accvgpr_read_b32 v236, a68
    v_accvgpr_read_b32 v237, a69
    v_accvgpr_read_b32 v238, a70
    v_accvgpr_read_b32 v239, a71
    v_pk_mul_f32 v[236:237], v[236:237], v[246:247] op_sel_hi:[1,0]
    v_pk_mul_f32 v[238:239], v[238:239], v[246:247] op_sel_hi:[1,0]
    v_accvgpr_write_b32 a68, v236
    v_accvgpr_write_b32 a69, v237
    v_accvgpr_write_b32 a70, v238
    v_accvgpr_write_b32 a71, v239
    v_accvgpr_read_b32 v236, a72
    v_accvgpr_read_b32 v237, a73
    v_accvgpr_read_b32 v238, a74
    v_accvgpr_read_b32 v239, a75
    v_pk_mul_f32 v[236:237], v[236:237], v[248:249] op_sel_hi:[1,0]
    v_pk_mul_f32 v[238:239], v[238:239], v[248:249] op_sel_hi:[1,0]
    v_accvgpr_write_b32 a72, v236
    v_accvgpr_write_b32 a73, v237
    v_accvgpr_write_b32 a74, v238
    v_accvgpr_write_b32 a75, v239
    v_accvgpr_read_b32 v236, a76
    v_accvgpr_read_b32 v237, a77
    v_accvgpr_read_b32 v238, a78
    v_accvgpr_read_b32 v239, a79
    v_pk_mul_f32 v[236:237], v[236:237], v[250:251] op_sel_hi:[1,0]
    v_pk_mul_f32 v[238:239], v[238:239], v[250:251] op_sel_hi:[1,0]
    v_accvgpr_write_b32 a76, v236
    v_accvgpr_write_b32 a77, v237
    v_accvgpr_write_b32 a78, v238
    v_accvgpr_write_b32 a79, v239
    v_accvgpr_read_b32 v236, a80
    v_accvgpr_read_b32 v237, a81
    v_accvgpr_read_b32 v238, a82
    v_accvgpr_read_b32 v239, a83
    v_pk_mul_f32 v[236:237], v[236:237], v[218:219] op_sel_hi:[1,0]
    v_pk_mul_f32 v[238:239], v[238:239], v[218:219] op_sel_hi:[1,0]
    v_accvgpr_write_b32 a80, v236
    v_accvgpr_write_b32 a81, v237
    v_accvgpr_write_b32 a82, v238
    v_accvgpr_write_b32 a83, v239
    v_accvgpr_read_b32 v236, a84
    v_accvgpr_read_b32 v237, a85
    v_accvgpr_read_b32 v238, a86
    v_accvgpr_read_b32 v239, a87
    v_pk_mul_f32 v[236:237], v[236:237], v[220:221] op_sel_hi:[1,0]
    v_pk_mul_f32 v[238:239], v[238:239], v[220:221] op_sel_hi:[1,0]
    v_accvgpr_write_b32 a84, v236
    v_accvgpr_write_b32 a85, v237
    v_accvgpr_write_b32 a86, v238
    v_accvgpr_write_b32 a87, v239
    v_accvgpr_read_b32 v236, a88
    v_accvgpr_read_b32 v237, a89
    v_accvgpr_read_b32 v238, a90
    v_accvgpr_read_b32 v239, a91
    v_pk_mul_f32 v[236:237], v[236:237], v[246:247] op_sel_hi:[1,0]
    v_pk_mul_f32 v[238:239], v[238:239], v[246:247] op_sel_hi:[1,0]
    v_accvgpr_write_b32 a88, v236
    v_accvgpr_write_b32 a89, v237
    v_accvgpr_write_b32 a90, v238
    v_accvgpr_write_b32 a91, v239
    v_accvgpr_read_b32 v236, a92
    v_accvgpr_read_b32 v237, a93
    v_accvgpr_read_b32 v238, a94
    v_accvgpr_read_b32 v239, a95
    v_pk_mul_f32 v[236:237], v[236:237], v[248:249] op_sel_hi:[1,0]
    v_pk_mul_f32 v[238:239], v[238:239], v[248:249] op_sel_hi:[1,0]
    v_accvgpr_write_b32 a92, v236
    v_accvgpr_write_b32 a93, v237
    v_accvgpr_write_b32 a94, v238
    v_accvgpr_write_b32 a95, v239
    v_accvgpr_read_b32 v236, a96
    v_accvgpr_read_b32 v237, a97
    v_accvgpr_read_b32 v238, a98
    v_accvgpr_read_b32 v239, a99
    v_pk_mul_f32 v[236:237], v[236:237], v[250:251] op_sel_hi:[1,0]
    v_pk_mul_f32 v[238:239], v[238:239], v[250:251] op_sel_hi:[1,0]
    v_accvgpr_write_b32 a96, v236
    v_accvgpr_write_b32 a97, v237
    v_accvgpr_write_b32 a98, v238
    v_accvgpr_write_b32 a99, v239
    v_accvgpr_read_b32 v236, a100
    v_accvgpr_read_b32 v237, a101
    v_accvgpr_read_b32 v238, a102
    v_accvgpr_read_b32 v239, a103
    v_pk_mul_f32 v[236:237], v[236:237], v[218:219] op_sel_hi:[1,0]
    v_pk_mul_f32 v[238:239], v[238:239], v[218:219] op_sel_hi:[1,0]
    v_accvgpr_write_b32 a100, v236
    v_accvgpr_write_b32 a101, v237
    v_accvgpr_write_b32 a102, v238
    v_accvgpr_write_b32 a103, v239
    v_accvgpr_read_b32 v236, a104
    v_accvgpr_read_b32 v237, a105
    v_accvgpr_read_b32 v238, a106
    v_accvgpr_read_b32 v239, a107
    v_pk_mul_f32 v[236:237], v[236:237], v[220:221] op_sel_hi:[1,0]
    v_pk_mul_f32 v[238:239], v[238:239], v[220:221] op_sel_hi:[1,0]
    v_accvgpr_write_b32 a104, v236
    v_accvgpr_write_b32 a105, v237
    v_accvgpr_write_b32 a106, v238
    v_accvgpr_write_b32 a107, v239
    v_accvgpr_read_b32 v236, a108
    v_accvgpr_read_b32 v237, a109
    v_accvgpr_read_b32 v238, a110
    v_accvgpr_read_b32 v239, a111
    v_pk_mul_f32 v[236:237], v[236:237], v[246:247] op_sel_hi:[1,0]
    v_pk_mul_f32 v[238:239], v[238:239], v[246:247] op_sel_hi:[1,0]
    v_accvgpr_write_b32 a108, v236
    v_accvgpr_write_b32 a109, v237
    v_accvgpr_write_b32 a110, v238
    v_accvgpr_write_b32 a111, v239
    v_accvgpr_read_b32 v236, a112
    v_accvgpr_read_b32 v237, a113
    v_accvgpr_read_b32 v238, a114
    v_accvgpr_read_b32 v239, a115
    v_pk_mul_f32 v[236:237], v[236:237], v[248:249] op_sel_hi:[1,0]
    v_pk_mul_f32 v[238:239], v[238:239], v[248:249] op_sel_hi:[1,0]
    v_accvgpr_write_b32 a112, v236
    v_accvgpr_write_b32 a113, v237
    v_accvgpr_write_b32 a114, v238
    v_accvgpr_write_b32 a115, v239
    v_accvgpr_read_b32 v236, a116
    v_accvgpr_read_b32 v237, a117
    v_accvgpr_read_b32 v238, a118
    v_accvgpr_read_b32 v239, a119
    v_pk_mul_f32 v[236:237], v[236:237], v[250:251] op_sel_hi:[1,0]
    v_pk_mul_f32 v[238:239], v[238:239], v[250:251] op_sel_hi:[1,0]
    v_accvgpr_write_b32 a116, v236
    v_accvgpr_write_b32 a117, v237
    v_accvgpr_write_b32 a118, v238
    v_accvgpr_write_b32 a119, v239
    v_accvgpr_read_b32 v236, a120
    v_accvgpr_read_b32 v237, a121
    v_accvgpr_read_b32 v238, a122
    v_accvgpr_read_b32 v239, a123
    v_pk_mul_f32 v[236:237], v[236:237], v[218:219] op_sel_hi:[1,0]
    v_pk_mul_f32 v[238:239], v[238:239], v[218:219] op_sel_hi:[1,0]
    v_accvgpr_write_b32 a120, v236
    v_accvgpr_write_b32 a121, v237
    v_accvgpr_write_b32 a122, v238
    v_accvgpr_write_b32 a123, v239
    v_accvgpr_read_b32 v236, a124
    v_accvgpr_read_b32 v237, a125
    v_accvgpr_read_b32 v238, a126
    v_accvgpr_read_b32 v239, a127
    v_pk_mul_f32 v[236:237], v[236:237], v[220:221] op_sel_hi:[1,0]
    v_pk_mul_f32 v[238:239], v[238:239], v[220:221] op_sel_hi:[1,0]
    v_accvgpr_write_b32 a124, v236
    v_accvgpr_write_b32 a125, v237
    v_accvgpr_write_b32 a126, v238
    v_accvgpr_write_b32 a127, v239
    v_accvgpr_read_b32 v236, a128
    v_accvgpr_read_b32 v237, a129
    v_accvgpr_read_b32 v238, a130
    v_accvgpr_read_b32 v239, a131
    v_pk_mul_f32 v[236:237], v[236:237], v[246:247] op_sel_hi:[1,0]
    v_pk_mul_f32 v[238:239], v[238:239], v[246:247] op_sel_hi:[1,0]
    v_accvgpr_write_b32 a128, v236
    v_accvgpr_write_b32 a129, v237
    v_accvgpr_write_b32 a130, v238
    v_accvgpr_write_b32 a131, v239
    v_accvgpr_read_b32 v236, a132
    v_accvgpr_read_b32 v237, a133
    v_accvgpr_read_b32 v238, a134
    v_accvgpr_read_b32 v239, a135
    v_pk_mul_f32 v[236:237], v[236:237], v[248:249] op_sel_hi:[1,0]
    v_pk_mul_f32 v[238:239], v[238:239], v[248:249] op_sel_hi:[1,0]
    v_accvgpr_write_b32 a132, v236
    v_accvgpr_write_b32 a133, v237
    v_accvgpr_write_b32 a134, v238
    v_accvgpr_write_b32 a135, v239
    v_accvgpr_read_b32 v236, a136
    v_accvgpr_read_b32 v237, a137
    v_accvgpr_read_b32 v238, a138
    v_accvgpr_read_b32 v239, a139
    v_pk_mul_f32 v[236:237], v[236:237], v[250:251] op_sel_hi:[1,0]
    v_pk_mul_f32 v[238:239], v[238:239], v[250:251] op_sel_hi:[1,0]
    v_accvgpr_write_b32 a136, v236
    v_accvgpr_write_b32 a137, v237
    v_accvgpr_write_b32 a138, v238
    v_accvgpr_write_b32 a139, v239
    v_accvgpr_read_b32 v236, a140
    v_accvgpr_read_b32 v237, a141
    v_accvgpr_read_b32 v238, a142
    v_accvgpr_read_b32 v239, a143
    v_pk_mul_f32 v[236:237], v[236:237], v[218:219] op_sel_hi:[1,0]
    v_pk_mul_f32 v[238:239], v[238:239], v[218:219] op_sel_hi:[1,0]
    v_accvgpr_write_b32 a140, v236
    v_accvgpr_write_b32 a141, v237
    v_accvgpr_write_b32 a142, v238
    v_accvgpr_write_b32 a143, v239
    v_accvgpr_read_b32 v236, a144
    v_accvgpr_read_b32 v237, a145
    v_accvgpr_read_b32 v238, a146
    v_accvgpr_read_b32 v239, a147
    v_pk_mul_f32 v[236:237], v[236:237], v[220:221] op_sel_hi:[1,0]
    v_pk_mul_f32 v[238:239], v[238:239], v[220:221] op_sel_hi:[1,0]
    v_accvgpr_write_b32 a144, v236
    v_accvgpr_write_b32 a145, v237
    v_accvgpr_write_b32 a146, v238
    v_accvgpr_write_b32 a147, v239
    v_accvgpr_read_b32 v236, a148
    v_accvgpr_read_b32 v237, a149
    v_accvgpr_read_b32 v238, a150
    v_accvgpr_read_b32 v239, a151
    v_pk_mul_f32 v[236:237], v[236:237], v[246:247] op_sel_hi:[1,0]
    v_pk_mul_f32 v[238:239], v[238:239], v[246:247] op_sel_hi:[1,0]
    v_accvgpr_write_b32 a148, v236
    v_accvgpr_write_b32 a149, v237
    v_accvgpr_write_b32 a150, v238
    v_accvgpr_write_b32 a151, v239
    v_accvgpr_read_b32 v236, a152
    v_accvgpr_read_b32 v237, a153
    v_accvgpr_read_b32 v238, a154
    v_accvgpr_read_b32 v239, a155
    v_pk_mul_f32 v[236:237], v[236:237], v[248:249] op_sel_hi:[1,0]
    v_pk_mul_f32 v[238:239], v[238:239], v[248:249] op_sel_hi:[1,0]
    v_accvgpr_write_b32 a152, v236
    v_accvgpr_write_b32 a153, v237
    v_accvgpr_write_b32 a154, v238
    v_accvgpr_write_b32 a155, v239
    v_accvgpr_read_b32 v236, a156
    v_accvgpr_read_b32 v237, a157
    v_accvgpr_read_b32 v238, a158
    v_accvgpr_read_b32 v239, a159
    v_pk_mul_f32 v[236:237], v[236:237], v[250:251] op_sel_hi:[1,0]
    v_pk_mul_f32 v[238:239], v[238:239], v[250:251] op_sel_hi:[1,0]
    v_accvgpr_write_b32 a156, v236
    v_accvgpr_write_b32 a157, v237
    v_accvgpr_write_b32 a158, v238
    v_accvgpr_write_b32 a159, v239
    v_pk_mul_f32 v[180:181], v[180:181], v[218:219] op_sel_hi:[1,0]
    v_pk_mul_f32 v[182:183], v[182:183], v[218:219] op_sel_hi:[1,0]
    v_pk_mul_f32 v[184:185], v[184:185], v[220:221] op_sel_hi:[1,0]
    v_pk_mul_f32 v[186:187], v[186:187], v[220:221] op_sel_hi:[1,0]
    v_pk_mul_f32 v[188:189], v[188:189], v[246:247] op_sel_hi:[1,0]
    v_pk_mul_f32 v[190:191], v[190:191], v[246:247] op_sel_hi:[1,0]
    v_pk_mul_f32 v[192:193], v[192:193], v[248:249] op_sel_hi:[1,0]
    v_pk_mul_f32 v[194:195], v[194:195], v[248:249] op_sel_hi:[1,0]
    v_pk_mul_f32 v[196:197], v[196:197], v[250:251] op_sel_hi:[1,0]
    v_pk_mul_f32 v[198:199], v[198:199], v[250:251] op_sel_hi:[1,0]
    s_setpc_b64 s[50:51]
S_odmb:
    s_add_u32 m0, s43, 0
    s_add_u32 s39, s46, 0
    buffer_load_dwordx4 v244, s[16:19], s39 offen lds
    s_add_u32 m0, s43, 1056
    s_add_u32 s39, s46, 5120
    buffer_load_dwordx4 v244, s[16:19], s39 offen lds
    s_add_u32 m0, s43, 2112
    s_add_u32 s39, s46, 1280
    buffer_load_dwordx4 v244, s[16:19], s39 offen lds
    s_add_u32 m0, s43, 3168
    s_add_u32 s39, s46, 6400
    buffer_load_dwordx4 v244, s[16:19], s39 offen lds
    s_add_u32 m0, s43, 4224
    s_add_u32 s39, s46, 2560
    buffer_load_dwordx4 v244, s[16:19], s39 offen lds
    s_add_u32 m0, s43, 5280
    s_add_u32 s39, s46, 7680
    buffer_load_dwordx4 v244, s[16:19], s39 offen lds
    s_add_u32 m0, s43, 6336
    s_add_u32 s39, s46, 3840
    buffer_load_dwordx4 v244, s[16:19], s39 offen lds
    s_add_u32 m0, s43, 7392
    s_add_u32 s39, s46, 8960
    buffer_load_dwordx4 v244, s[16:19], s39 offen lds
    s_setpc_b64 s[50:51]
S_spin:
    buffer_load_dword v250, v249, s[68:71], s59 offen sc1
    s_waitcnt vmcnt(0)
S_spinc:
    v_readfirstlane_b32 s39, v250
    s_nop 1
    s_cmp_eq_u32 s39, 8
    s_cbranch_scc1 L_spr
    s_sleep 4
    s_branch S_spin
L_spr:
    s_setpc_b64 s[50:51]
S_post:
    s_cmp_lg_u32 s28, 0
    s_cbranch_scc1 L_pr
    v_mov_b32 v251, 1
    s_mov_b64 exec, 1
    buffer_atomic_add v251, v249, s[68:71], s44 offen sc1
    s_mov_b64 exec, -1
L_pr:
    s_setpc_b64 s[50:51]
S_ld:
    s_add_u32 s39, s55, 0
    buffer_load_dwordx4 v[160:163], v247, s[60:63], s39 offen sc1
    s_add_u32 s39, s55, 819200
    buffer_load_dwordx4 v[164:167], v247, s[60:63], s39 offen sc1
    s_add_u32 s39, s55, 4096
    buffer_load_dwordx4 v[168:171], v247, s[60:63], s39 offen sc1
    s_add_u32 s39, s55, 823296
    buffer_load_dwordx4 v[172:175], v247, s[60:63], s39 offen sc1
    s_add_u32 s39, s55, 8192
    buffer_load_dwordx4 v[176:179], v247, s[60:63], s39 offen sc1
    s_add_u32 s39, s55, 827392
    buffer_load_dwordx4 v[180:183], v247, s[60:63], s39 offen sc1
    s_add_u32 s39, s55, 12288
    buffer_load_dwordx4 v[184:187], v247, s[60:63], s39 offen sc1
    s_add_u32 s39, s55, 831488
    buffer_load_dwordx4 v[188:191], v247, s[60:63], s39 offen sc1
    s_add_u32 s39, s55, 16384
    buffer_load_dwordx4 v[192:195], v247, s[60:63], s39 offen sc1
    s_add_u32 s39, s55, 835584
    buffer_load_dwordx4 v[196:199], v247, s[60:63], s39 offen sc1
    s_waitcnt vmcnt(0)
S_reda:
    v_mfma_f32_16x16x32_bf16 v[200:203], v[224:227], v[160:163], 0
    v_mfma_f32_16x16x32_bf16 v[200:203], v[224:227], v[164:167], v[200:203]
    v_mfma_f32_16x16x32_bf16 v[200:203], v[228:231], v[168:171], v[200:203]
    v_mfma_f32_16x16x32_bf16 v[200:203], v[228:231], v[172:175], v[200:203]
S_redb:
    v_mfma_f32_16x16x32_bf16 v[204:207], v[224:227], v[176:179], 0
    v_mfma_f32_16x16x32_bf16 v[204:207], v[224:227], v[180:183], v[204:207]
    v_mfma_f32_16x16x32_bf16 v[204:207], v[228:231], v[184:187], v[204:207]
    v_mfma_f32_16x16x32_bf16 v[204:207], v[228:231], v[188:191], v[204:207]
    v_mfma_f32_16x16x32_bf16 v[208:211], v[224:227], v[192:195], 0
    v_mfma_f32_16x16x32_bf16 v[208:211], v[224:227], v[196:199], v[208:211]
    s_nop 1
    v_cvt_pk_bf16_f32 v200, v200, v201
    v_cvt_pk_bf16_f32 v201, v202, v203
    s_add_u32 s44, s56, 0
    buffer_store_dwordx2 v[200:201], v248, s[72:75], s44 offen
    v_cvt_pk_bf16_f32 v204, v204, v205
    v_cvt_pk_bf16_f32 v205, v206, v207
    s_add_u32 s44, s56, 40960
    buffer_store_dwordx2 v[204:205], v248, s[72:75], s44 offen
    v_cvt_pk_bf16_f32 v208, v208, v209
    v_cvt_pk_bf16_f32 v209, v210, v211
    s_add_u32 s44, s56, 81920
    buffer_store_dwordx2 v[208:209], v222, s[72:75], s44 offen
    s_setpc_b64 s[50:51]
L_fi:
    buffer_store_dwordx4 v[232:235], v204, s[68:71], 0 offen sc1
    s_waitcnt vmcnt(0)
    s_lshl_b32 s39, s29, 3
    v_mov_b32 v196, s39
    v_mov_b32 v197, 1
    s_mov_b64 exec, 1
    buffer_atomic_add v197, v196, s[76:79], 0 offen sc1
    s_mov_b64 exec, -1
    s_branch L_fib
L_Q_en:
    v_mov_b32 v221, v209
    v_xor_b32 v247, 0x6000, v208
    s_branch L_Q_enb
L_rrz0:
    s_call_b64 s[50:51], S_rare1
    s_branch L_rbz0
L_p2z0:
    s_call_b64 s[50:51], S_scale
    s_branch L_pbz0
L_rrl1:
    s_call_b64 s[50:51], S_rare0
    s_branch L_rbl1
L_p2l1:
    s_call_b64 s[50:51], S_scale
    s_branch L_pbl1
L_rrl2:
    s_call_b64 s[50:51], S_rare1
    s_branch L_rbl2
L_p2l2:
    s_call_b64 s[50:51], S_scale
    s_branch L_pbl2
L_rrl3:
    s_call_b64 s[50:51], S_rare0
    s_branch L_rbl3
L_p2l3:
    s_call_b64 s[50:51], S_scale
    s_branch L_pbl3
L_rrl0:
    s_call_b64 s[50:51], S_rare1
    s_branch L_rbl0
L_p2l0:
    s_call_b64 s[50:51], S_scale
    s_branch L_pbl0
L_rre13:
    s_call_b64 s[50:51], S_rare0
    s_branch L_rbe13
L_p2e13:
    s_call_b64 s[50:51], S_scale
    s_branch L_pbe13
L_s0a:
    s_mov_b32 s39, 0
    buffer_load_dwordx4 v[252:255], v242, s[16:19], s39 offen
    s_mov_b32 s39, 163840
    buffer_load_dwordx4 v[252:255], v242, s[16:19], s39 offen
    s_mov_b32 s39, 327680
    buffer_load_dwordx4 v[252:255], v242, s[16:19], s39 offen
    s_mov_b32 s39, 491520
    buffer_load_dwordx4 v[252:255], v242, s[16:19], s39 offen
    s_branch L_s0b
L_s1a:
    s_mov_b32 s39, 256
    buffer_load_dwordx4 v[252:255], v242, s[16:19], s39 offen
    s_mov_b32 s39, 164096
    buffer_load_dwordx4 v[252:255], v242, s[16:19], s39 offen
    s_mov_b32 s39, 327936
    buffer_load_dwordx4 v[252:255], v242, s[16:19], s39 offen
    s_branch L_s1b
L_rre14:
    s_call_b64 s[50:51], S_rare1
    s_branch L_rbe14
L_s2a:
    s_mov_b32 s39, 491776
    buffer_load_dwordx4 v[252:255], v242, s[16:19], s39 offen
    s_mov_b32 s39, 512
    buffer_load_dwordx4 v[252:255], v242, s[16:19], s39 offen
    s_mov_b32 s39, 164352
    buffer_load_dwordx4 v[252:255], v242, s[16:19], s39 offen
    s_branch L_s2b
L_p2e14:
    s_call_b64 s[50:51], S_scale
    s_branch L_pbe14
L_s3a:
    s_mov_b32 s39, 328192
    buffer_load_dwordx4 v[252:255], v242, s[16:19], s39 offen
    s_mov_b32 s39, 492032
    buffer_load_dwordx4 v[252:255], v242, s[16:19], s39 offen
    s_mov_b32 s39, 768
    buffer_load_dwordx4 v[252:255], v242, s[16:19], s39 offen
    s_branch L_s3b
L_s4a:
    s_mov_b32 s39, 164608
    buffer_load_dwordx4 v[252:255], v242, s[16:19], s39 offen
    s_mov_b32 s39, 328448
    buffer_load_dwordx4 v[252:255], v242, s[16:19], s39 offen
    s_mov_b32 s39, 492288
    buffer_load_dwordx4 v[252:255], v242, s[16:19], s39 offen
    s_branch L_s4b
L_s5a:
    s_mov_b32 s39, 1024
    buffer_load_dwordx4 v[252:255], v242, s[16:19], s39 offen
    s_mov_b32 s39, 164864
    buffer_load_dwordx4 v[252:255], v242, s[16:19], s39 offen
    s_mov_b32 s39, 328704
    buffer_load_dwordx4 v[252:255], v242, s[16:19], s39 offen
    s_mov_b32 s39, 492544
    buffer_load_dwordx4 v[252:255], v242, s[16:19], s39 offen
    s_branch L_s5b
L_s6a:
    s_branch L_s6b
L_s7a:
    s_mul_i32 s38, s28, 40960
    s_add_u32 s43, s37, 0
    s_mov_b32 s46, s38
    s_add_u32 m0, s43, 0
    s_add_u32 s39, s46, 0
    buffer_load_dwordx4 v243, s[16:19], s39 offen lds
    s_add_u32 m0, s43, 1056
    s_add_u32 s39, s46, 5120
    buffer_load_dwordx4 v243, s[16:19], s39 offen lds
    s_add_u32 m0, s43, 2112
    s_add_u32 s39, s46, 1280
    buffer_load_dwordx4 v243, s[16:19], s39 offen lds
    s_add_u32 m0, s43, 3168
    s_add_u32 s39, s46, 6400
    buffer_load_dwordx4 v243, s[16:19], s39 offen lds
    s_add_u32 m0, s43, 4224
    s_add_u32 s39, s46, 2560
    buffer_load_dwordx4 v243, s[16:19], s39 offen lds
    s_add_u32 m0, s43, 5280
    s_add_u32 s39, s46, 7680
    buffer_load_dwordx4 v243, s[16:19], s39 offen lds
    s_add_u32 m0, s43, 6336
    s_add_u32 s39, s46, 3840
    buffer_load_dwordx4 v243, s[16:19], s39 offen lds
    s_add_u32 m0, s43, 7392
    s_add_u32 s39, s46, 8960
    buffer_load_dwordx4 v243, s[16:19], s39 offen lds
    s_branch L_s7b
L_s8a:
    s_add_u32 s43, s37, 67584
    s_add_u32 s46, s38, 327680
    s_add_u32 m0, s43, 0
    s_add_u32 s39, s46, 0
    buffer_load_dwordx4 v243, s[16:19], s39 offen lds
    s_add_u32 m0, s43, 1056
    s_add_u32 s39, s46, 5120
    buffer_load_dwordx4 v243, s[16:19], s39 offen lds
    s_add_u32 m0, s43, 2112
    s_add_u32 s39, s46, 1280
    buffer_load_dwordx4 v243, s[16:19], s39 offen lds
    s_add_u32 m0, s43, 3168
    s_add_u32 s39, s46, 6400
    buffer_load_dwordx4 v243, s[16:19], s39 offen lds
    s_add_u32 m0, s43, 4224
    s_add_u32 s39, s46, 2560
    buffer_load_dwordx4 v243, s[16:19], s39 offen lds
    s_add_u32 m0, s43, 5280
    s_add_u32 s39, s46, 7680
    buffer_load_dwordx4 v243, s[16:19], s39 offen lds
    s_add_u32 m0, s43, 6336
    s_add_u32 s39, s46, 3840
    buffer_load_dwordx4 v243, s[16:19], s39 offen lds
    s_add_u32 m0, s43, 7392
    s_add_u32 s39, s46, 8960
    buffer_load_dwordx4 v243, s[16:19], s39 offen lds
    s_branch L_s8b
L_T_ck:
    s_waitcnt vmcnt(13)
    s_call_b64 s[50:51], S_spinc
    s_sub_u32 s55, s31, 2
    s_mul_i32 s55, s55, 40960
    s_add_u32 s59, s59, 128
    v_mov_b32 v247, v240
    s_cmp_lg_u32 s31, 4
    s_cbranch_scc1 L_T_ckb
    v_mov_b32 v243, 2146435072
    v_mov_b32 v244, 2146435072
    s_mov_b32 s48, 0x28000
    s_branch L_T_ckb
L_code_end:
    s_endpgm
.section .rodata,"a"
.p2align 6
.amdhsa_kernel standalone__mha_block_cached__near_ridge_kernel
  .amdhsa_next_free_vgpr 512
  .amdhsa_next_free_sgpr 80
  .amdhsa_accum_offset 256
  .amdhsa_group_segment_fixed_size 0
  .amdhsa_kernarg_size 64
  .amdhsa_user_sgpr_count 2
  .amdhsa_user_sgpr_kernarg_segment_ptr 1
  .amdhsa_system_sgpr_workgroup_id_x 1
.end_amdhsa_kernel
```
